```python
import torch

def _softmax(x, axis=-1):
    return torch.softmax(x, dim=axis)
def _gelu(x):
    return torch.nn.functional.gelu(x, approximate="tanh")
def _silu(x):
    return torch.nn.functional.silu(x)
def _sigmoid(x):
    return torch.sigmoid(x)
def _layernorm(x, axis=-1, eps=1e-5):
    m = x.mean(dim=axis, keepdim=True)
    v = x.var(dim=axis, keepdim=True, unbiased=False)
    return (x - m) / torch.sqrt(v + eps)
def _scatter_add(tgt, idx, src, axis=0):
    return tgt.clone().index_add_(axis, idx, src)
def _segment_sum(src, seg, n):
    out = torch.zeros((n,) + src.shape[1:], dtype=src.dtype)
    return out.index_add_(0, seg, src)
def _pad(x, pw):
    flat = tuple(v for pair in reversed(pw) for v in pair)
    return torch.nn.functional.pad(x, flat)

kernel_name = 'sequential_preLN__gqa_block_cached__glu_gated_bilinear__decode'

def setup_inputs():

    _w = (lambda a: (lambda t: t.to(torch.bfloat16) if t.is_floating_point() else t)(torch.as_tensor(a)))
    def _A_setup():
        B, Sq, D = 1, 1, 512
        Hq, Hkv, Sk, Dh = 32, 32, 32768, 128
        assert Hq % Hkv == 0, (Hq, Hkv)
        return {
            "x": _w((lambda *s: torch.randn(*s, dtype=torch.bfloat16) * 0.05)(B, Sq, D)),
            "k_cache": _w((lambda *s: torch.randn(*s, dtype=torch.bfloat16) * 3.2)(B, Hkv, Sk, Dh)),
            "v_cache": _w((lambda *s: torch.randn(*s, dtype=torch.bfloat16) * 1.6)(B, Hkv, Sk, Dh)),
            "wq": _w((lambda *s: torch.randn(*s, dtype=torch.bfloat16) * 3.2)(D, Hq * Dh) * (D ** -0.5)),
            "wo": _w((lambda *s: torch.randn(*s, dtype=torch.bfloat16) * 1.6)(Hq * Dh, D) * ((Hq * Dh) ** -0.5)),
        }
    _A_in = _A_setup()

    def _B_setup():
        B, S, D, F = 1, 1, 512, 1376
        return {
            "x": _w((lambda *s: torch.randn(*s, dtype=torch.bfloat16) * 0.05)(B, S, D)),
            "w_gate": _w((lambda *s: torch.randn(*s, dtype=torch.bfloat16) * 1.6)(D, F) * (D ** -0.5)),
            "w_up": _w((lambda *s: torch.randn(*s, dtype=torch.bfloat16) * 1.6)(D, F) * (D ** -0.5)),
            "w_down": _w((lambda *s: torch.randn(*s, dtype=torch.bfloat16) * 1.6)(F, D) * (F ** -0.5)),
        }
    _B_in = _B_setup()

    return {
        "A_x": _A_in["x"],
        "A_k_cache": _A_in["k_cache"],
        "A_v_cache": _A_in["v_cache"],
        "A_wq": _A_in["wq"],
        "A_wo": _A_in["wo"],
        "B_x": _B_in["x"],
        "B_w_gate": _B_in["w_gate"],
        "B_w_up": _B_in["w_up"],
        "B_w_down": _B_in["w_down"],
    }

def reference(A_x, A_k_cache, A_v_cache, A_wq, A_wo, B_x, B_w_gate, B_w_up, B_w_down):
    def _A_ref(x, k_cache, v_cache, wq, wo):
        B, Sq, D = x.shape
        Hq, Dh = 32, 128
        Hkv = k_cache.shape[1]
        rep = Hq // Hkv
        q = (lambda x, *d: x.permute(*d))((x @ wq).reshape(B, Sq, Hq, Dh), 0, 2, 1, 3)
        k = (lambda x, n, axis: torch.repeat_interleave(x, n, dim=axis))(k_cache, rep, axis=1)
        v = (lambda x, n, axis: torch.repeat_interleave(x, n, dim=axis))(v_cache, rep, axis=1)
        scores = torch.einsum("bhqd,bhkd->bhqk", q, k) * (Dh ** -0.5)
        p = _softmax(scores, axis=-1)
        o = torch.einsum("bhqk,bhkd->bhqd", p, v)
        return (lambda x, *d: x.permute(*d))(o, 0, 2, 1, 3).reshape(B, Sq, Hq * Dh) @ wo

    def _B_ref(x, w_gate, w_up, w_down):
        g = torch.einsum("bsd,df->bsf", x, w_gate)
        u = torch.einsum("bsd,df->bsf", x, w_up)
        h = g * u
        return torch.einsum("bsf,fd->bsd", h, w_down)

    x = A_x
    h = x + _A_ref(_layernorm(x, axis=-1), A_k_cache, A_v_cache, A_wq, A_wo)
    h2 = h + _B_ref(_layernorm(h, axis=-1), B_w_gate, B_w_up, B_w_down)
    return h2
```

```asm
; @launch grid=(256,1,1) block=(576,1,1) lds=162304
.amdgcn_target "amdgcn-amd-amdhsa--gfx950"
.text
.globl sequential_preLN__gqa_block_cached__glu_gated_bilinear__decode_kernel
.p2align 8
.type sequential_preLN__gqa_block_cached__glu_gated_bilinear__decode_kernel,@function
sequential_preLN__gqa_block_cached__glu_gated_bilinear__decode_kernel:
    s_cmp_ge_u32 s2, 256
    s_cbranch_scc1 L_end
    s_load_dwordx16 s[4:19], s[0:1], 0
    s_load_dwordx8 s[20:27], s[0:1], 64
    v_lshrrev_b32 v2, 6, v0
    v_and_b32 v1, 63, v0
    v_readfirstlane_b32 s28, v2
    s_lshr_b32 s29, s2, 3
    s_add_u32 s30, s2, s29
    s_and_b32 s30, s30, 7
    s_lshl_b32 s3, s29, 3
    s_add_u32 s3, s3, s30
    s_mov_b32 s31, s30
    s_mov_b32 s89, 262144
    s_waitcnt lgkmcnt(0)
    s_cmp_eq_u32 s28, 0
    s_cbranch_scc1 L_loader
    s_cmp_lt_u32 s28, 5
    s_cbranch_scc1 L_consumer
    s_branch L_tail
L_loader:
    s_setprio 3
    s_mov_b32 s32, s6
    s_and_b32 s33, s7, 0xffff
    s_mov_b32 s34, 0x10000000
    s_mov_b32 s35, 0x20000
    s_mov_b32 s36, s8
    s_and_b32 s37, s9, 0xffff
    s_mov_b32 s38, 0x10000000
    s_mov_b32 s39, 0x20000
    s_lshl_b32 s44, s29, 23
    v_lshrrev_b32 v8, 4, v1
    v_and_b32 v9, 15, v1
    v_lshlrev_b32 v10, 8, v8
    v_add_u32 v10, s44, v10
    v_add_u32 v11, 0, v8
    v_xor_b32 v11, v11, v9
    v_lshlrev_b32 v11, 4, v11
    v_add_u32 v2, v10, v11
    v_add_u32 v11, 4, v8
    v_xor_b32 v11, v11, v9
    v_lshlrev_b32 v11, 4, v11
    v_add_u32 v3, v10, v11
    v_add_u32 v11, 8, v8
    v_xor_b32 v11, v11, v9
    v_lshlrev_b32 v11, 4, v11
    v_add_u32 v4, v10, v11
    v_add_u32 v11, 12, v8
    v_xor_b32 v11, v11, v9
    v_lshlrev_b32 v11, 4, v11
    v_add_u32 v5, v10, v11
    v_add_u32 v11, 0, v8
    v_lshlrev_b32 v11, 1, v11
    v_xor_b32 v11, v11, v9
    v_lshlrev_b32 v11, 4, v11
    v_add_u32 v6, v10, v11
    v_add_u32 v11, 4, v8
    v_lshlrev_b32 v11, 1, v11
    v_xor_b32 v11, v11, v9
    v_lshlrev_b32 v11, 4, v11
    v_add_u32 v7, v10, v11
    s_mul_i32 s46, s30, 1048576
    s_mov_b32 s48, 0
    s_mov_b32 s49, -3
    s_mov_b32 s50, 0
    v_mov_b32 v12, 147456
    v_mov_b32 v13, 147472
    buffer_load_dword v31, v6, s[36:39], s46 offen nt
    s_add_u32 s47, s46, 4096
    s_add_u32 m0, s48, 0
    s_waitcnt vmcnt(19)
    buffer_load_dwordx4 v2, s[32:35], s46 offen offset:0 nt lds
    s_waitcnt vmcnt(19)
    buffer_load_dwordx4 v3, s[32:35], s46 offen offset:1024 nt lds
    s_waitcnt vmcnt(19)
    buffer_load_dwordx4 v4, s[32:35], s46 offen offset:2048 nt lds
    s_waitcnt vmcnt(19)
    buffer_load_dwordx4 v5, s[32:35], s46 offen offset:3072 nt lds
    s_add_u32 m0, s48, 4096
    s_waitcnt vmcnt(19)
    buffer_load_dwordx4 v2, s[32:35], s47 offen offset:0 nt lds
    s_waitcnt vmcnt(19)
    buffer_load_dwordx4 v3, s[32:35], s47 offen offset:1024 nt lds
    s_waitcnt vmcnt(19)
    buffer_load_dwordx4 v4, s[32:35], s47 offen offset:2048 nt lds
    s_waitcnt vmcnt(19)
    s_add_u32 s49, s49, 1
    v_mov_b32 v14, s49
    buffer_load_dwordx4 v5, s[32:35], s47 offen offset:3072 nt lds
    s_add_u32 s50, s50, 1
    s_add_u32 s46, s46, 8192
    s_add_u32 s47, s46, 4096
    s_add_u32 s48, s48, 8192
    s_add_u32 m0, s48, 0
    s_waitcnt vmcnt(19)
    buffer_load_dwordx4 v2, s[32:35], s46 offen offset:0 nt lds
    s_waitcnt vmcnt(19)
    buffer_load_dwordx4 v3, s[32:35], s46 offen offset:1024 nt lds
    s_waitcnt vmcnt(19)
    buffer_load_dwordx4 v4, s[32:35], s46 offen offset:2048 nt lds
    s_waitcnt vmcnt(19)
    buffer_load_dwordx4 v5, s[32:35], s46 offen offset:3072 nt lds
    s_add_u32 m0, s48, 4096
    s_waitcnt vmcnt(19)
    buffer_load_dwordx4 v2, s[32:35], s47 offen offset:0 nt lds
    s_waitcnt vmcnt(19)
    buffer_load_dwordx4 v3, s[32:35], s47 offen offset:1024 nt lds
    s_waitcnt vmcnt(19)
    buffer_load_dwordx4 v4, s[32:35], s47 offen offset:2048 nt lds
    s_waitcnt vmcnt(19)
    s_add_u32 s49, s49, 1
    v_mov_b32 v14, s49
    buffer_load_dwordx4 v5, s[32:35], s47 offen offset:3072 nt lds
    v_mov_b32 v16, 0
    v_mov_b32 v17, 1
    v_mov_b32 v18, 2
    v_mov_b32 v19, 3
    v_mov_b32 v20, 0
    v_mov_b32 v21, 0
    v_mov_b32 v22, 0
    v_mov_b32 v23, 0
    v_mov_b32 v14, s49
    v_mov_b32 v15, 0x7fffffff
    ds_write_b64 v12, v[14:15]
    v_mov_b32 v24, 0x7fffffff
    v_mov_b32 v25, 0
    ds_write_b64 v12, v[24:25] offset:8
    ds_write_b128 v13, v[16:19]
    ds_write_b128 v13, v[20:23] offset:16
    ds_write_b128 v13, v[20:23] offset:32
    s_waitcnt lgkmcnt(0)
    s_barrier
    ds_read_b128 v[16:19], v13
L_ld_tile0:
    s_add_u32 s50, s50, 1
    s_add_u32 s46, s46, 8192
    s_add_u32 s47, s46, 4096
    s_add_u32 s48, s48, 8192
    s_cmp_ge_u32 s48, 131072
    s_cselect_b32 s48, 0, s48
    s_sub_u32 s52, s50, 15
L_ld_free0:
    s_sub_u32 s89, s89, 1
    s_cbranch_scc1 L_end
    s_waitcnt lgkmcnt(0)
    v_min3_u32 v20, v16, v17, v18
    v_min_u32 v20, v20, v19
    s_nop 0
    v_readfirstlane_b32 s51, v20
    ds_read_b128 v[16:19], v13
    s_cmp_ge_i32 s51, s52
    s_nop 2
    s_cbranch_scc0 L_ld_free0
    s_add_u32 m0, s48, 0
    s_waitcnt vmcnt(19)
    buffer_load_dwordx4 v2, s[32:35], s46 offen offset:0 nt lds
    s_waitcnt vmcnt(19)
    buffer_load_dwordx4 v3, s[32:35], s46 offen offset:1024 nt lds
    s_waitcnt vmcnt(19)
    buffer_load_dwordx4 v4, s[32:35], s46 offen offset:2048 nt lds
    s_waitcnt vmcnt(19)
    buffer_load_dwordx4 v5, s[32:35], s46 offen offset:3072 nt lds
    s_add_u32 m0, s48, 4096
    s_waitcnt vmcnt(19)
    buffer_load_dwordx4 v2, s[32:35], s47 offen offset:0 nt lds
    s_waitcnt vmcnt(19)
    buffer_load_dwordx4 v3, s[32:35], s47 offen offset:1024 nt lds
    s_waitcnt vmcnt(19)
    buffer_load_dwordx4 v4, s[32:35], s47 offen offset:2048 nt lds
    s_waitcnt vmcnt(19)
    s_add_u32 s49, s49, 1
    v_mov_b32 v14, s49
    ds_write_b32 v12, v14
    buffer_load_dwordx4 v5, s[32:35], s47 offen offset:3072 nt lds
    s_cmp_lt_u32 s50, 116
    s_cbranch_scc1 L_ld_tile0
    s_lshl_b32 s53, s29, 8
    s_add_u32 s53, s53, 557056
    v_mov_b32 v25, s53
    v_mov_b32 v26, 1
    s_mov_b64 exec, 1
    global_atomic_add v24, v25, v26, s[26:27] sc0 sc1
    s_mov_b64 exec, -1
    s_add_u32 s50, s50, 1
    s_add_u32 s46, s46, 8192
    s_add_u32 s47, s46, 4096
    s_add_u32 s48, s48, 8192
    s_cmp_ge_u32 s48, 131072
    s_cselect_b32 s48, 0, s48
    s_sub_u32 s52, s50, 15
L_ld_free1:
    s_sub_u32 s89, s89, 1
    s_cbranch_scc1 L_end
    s_waitcnt lgkmcnt(0)
    v_min3_u32 v20, v16, v17, v18
    v_min_u32 v20, v20, v19
    s_nop 0
    v_readfirstlane_b32 s51, v20
    ds_read_b128 v[16:19], v13
    s_cmp_ge_i32 s51, s52
    s_nop 2
    s_cbranch_scc0 L_ld_free1
    s_add_u32 m0, s48, 0
    s_waitcnt vmcnt(23)
    buffer_load_dwordx4 v2, s[32:35], s46 offen offset:0 nt lds
    s_waitcnt vmcnt(23)
    buffer_load_dwordx4 v3, s[32:35], s46 offen offset:1024 nt lds
    s_waitcnt vmcnt(23)
    buffer_load_dwordx4 v4, s[32:35], s46 offen offset:2048 nt lds
    s_waitcnt vmcnt(23)
    buffer_load_dwordx4 v5, s[32:35], s46 offen offset:3072 nt lds
    s_add_u32 m0, s48, 4096
    s_waitcnt vmcnt(23)
    buffer_load_dwordx4 v2, s[32:35], s47 offen offset:0 nt lds
    s_waitcnt vmcnt(23)
    buffer_load_dwordx4 v3, s[32:35], s47 offen offset:1024 nt lds
    s_waitcnt vmcnt(23)
    buffer_load_dwordx4 v4, s[32:35], s47 offen offset:2048 nt lds
    s_waitcnt vmcnt(23)
    s_add_u32 s49, s49, 1
    v_mov_b32 v14, s49
    ds_write_b32 v12, v14
    buffer_load_dwordx4 v5, s[32:35], s47 offen offset:3072 nt lds
    s_mov_b64 exec, 1
    global_atomic_add v27, v25, v26, s[26:27] sc0 sc1
    s_mov_b64 exec, -1
    s_add_u32 s50, s50, 1
    s_add_u32 s46, s46, 8192
    s_add_u32 s47, s46, 4096
    s_add_u32 s48, s48, 8192
    s_cmp_ge_u32 s48, 131072
    s_cselect_b32 s48, 0, s48
    s_sub_u32 s52, s50, 15
L_ld_free2:
    s_sub_u32 s89, s89, 1
    s_cbranch_scc1 L_end
    s_waitcnt lgkmcnt(0)
    v_min3_u32 v20, v16, v17, v18
    v_min_u32 v20, v20, v19
    s_nop 0
    v_readfirstlane_b32 s51, v20
    ds_read_b128 v[16:19], v13
    s_cmp_ge_i32 s51, s52
    s_nop 2
    s_cbranch_scc0 L_ld_free2
    s_add_u32 m0, s48, 0
    s_waitcnt vmcnt(23)
    buffer_load_dwordx4 v2, s[32:35], s46 offen offset:0 nt lds
    s_waitcnt vmcnt(23)
    buffer_load_dwordx4 v3, s[32:35], s46 offen offset:1024 nt lds
    s_waitcnt vmcnt(23)
    buffer_load_dwordx4 v4, s[32:35], s46 offen offset:2048 nt lds
    s_waitcnt vmcnt(23)
    buffer_load_dwordx4 v5, s[32:35], s46 offen offset:3072 nt lds
    s_add_u32 m0, s48, 4096
    s_waitcnt vmcnt(23)
    buffer_load_dwordx4 v2, s[32:35], s47 offen offset:0 nt lds
    s_waitcnt vmcnt(23)
    buffer_load_dwordx4 v3, s[32:35], s47 offen offset:1024 nt lds
    s_waitcnt vmcnt(23)
    buffer_load_dwordx4 v4, s[32:35], s47 offen offset:2048 nt lds
    s_waitcnt vmcnt(23)
    s_add_u32 s49, s49, 1
    v_mov_b32 v14, s49
    ds_write_b32 v12, v14
    buffer_load_dwordx4 v5, s[32:35], s47 offen offset:3072 nt lds
    s_mov_b64 exec, 1
    global_atomic_add v29, v25, v26, s[26:27] sc0 sc1
    s_mov_b64 exec, -1
    s_add_u32 s50, s50, 1
    s_add_u32 s46, s46, 8192
    s_add_u32 s47, s46, 4096
    s_add_u32 s48, s48, 8192
    s_cmp_ge_u32 s48, 131072
    s_cselect_b32 s48, 0, s48
    s_sub_u32 s52, s50, 15
L_ld_free3:
    s_sub_u32 s89, s89, 1
    s_cbranch_scc1 L_end
    s_waitcnt lgkmcnt(0)
    v_min3_u32 v20, v16, v17, v18
    v_min_u32 v20, v20, v19
    s_nop 0
    v_readfirstlane_b32 s51, v20
    ds_read_b128 v[16:19], v13
    s_cmp_ge_i32 s51, s52
    s_nop 2
    s_cbranch_scc0 L_ld_free3
    s_add_u32 m0, s48, 0
    s_waitcnt vmcnt(23)
    buffer_load_dwordx4 v2, s[32:35], s46 offen offset:0 nt lds
    s_waitcnt vmcnt(23)
    buffer_load_dwordx4 v3, s[32:35], s46 offen offset:1024 nt lds
    s_waitcnt vmcnt(23)
    buffer_load_dwordx4 v4, s[32:35], s46 offen offset:2048 nt lds
    s_waitcnt vmcnt(23)
    buffer_load_dwordx4 v5, s[32:35], s46 offen offset:3072 nt lds
    s_add_u32 m0, s48, 4096
    s_waitcnt vmcnt(23)
    buffer_load_dwordx4 v2, s[32:35], s47 offen offset:0 nt lds
    s_waitcnt vmcnt(23)
    buffer_load_dwordx4 v3, s[32:35], s47 offen offset:1024 nt lds
    s_waitcnt vmcnt(23)
    buffer_load_dwordx4 v4, s[32:35], s47 offen offset:2048 nt lds
    s_waitcnt vmcnt(23)
    s_add_u32 s49, s49, 1
    v_mov_b32 v14, s49
    ds_write_b32 v12, v14
    buffer_load_dwordx4 v5, s[32:35], s47 offen offset:3072 nt lds
L_ld_kdyn:
    v_readfirstlane_b32 s53, v24
    s_nop 0
    s_and_b32 s55, s53, 7
    s_lshr_b32 s57, s53, 3
    s_lshl_b32 s46, s55, 7
    s_add_u32 s46, s46, s57
    s_add_u32 s46, s46, 120
    s_lshl_b32 s46, s46, 13
    s_cmp_lt_u32 s53, 64
    s_cbranch_scc0 L_ld_kover
    s_mov_b32 s59, s53
    s_mov_b64 exec, 1
    global_atomic_add v24, v25, v26, s[26:27] sc0 sc1
    s_mov_b64 exec, -1
    s_add_u32 s50, s50, 1
    s_add_u32 s47, s46, 4096
    s_add_u32 s48, s48, 8192
    s_cmp_ge_u32 s48, 131072
    s_cselect_b32 s48, 0, s48
    s_sub_u32 s52, s50, 15
L_ld_free4:
    s_sub_u32 s89, s89, 1
    s_cbranch_scc1 L_end
    s_waitcnt lgkmcnt(0)
    v_min3_u32 v20, v16, v17, v18
    v_min_u32 v20, v20, v19
    s_nop 0
    v_readfirstlane_b32 s51, v20
    ds_read_b128 v[16:19], v13
    s_cmp_ge_i32 s51, s52
    s_nop 2
    s_cbranch_scc0 L_ld_free4
    s_lshr_b32 s53, s48, 11
    s_add_u32 s53, s53, 147584
    v_mov_b32 v21, s53
    v_mov_b32 v22, s59
    ds_write_b32 v21, v22
    s_add_u32 m0, s48, 0
    s_waitcnt vmcnt(23)
    buffer_load_dwordx4 v2, s[32:35], s46 offen offset:0 nt lds
    s_waitcnt vmcnt(23)
    buffer_load_dwordx4 v3, s[32:35], s46 offen offset:1024 nt lds
    s_waitcnt vmcnt(23)
    buffer_load_dwordx4 v4, s[32:35], s46 offen offset:2048 nt lds
    s_waitcnt vmcnt(23)
    buffer_load_dwordx4 v5, s[32:35], s46 offen offset:3072 nt lds
    s_add_u32 m0, s48, 4096
    s_waitcnt vmcnt(23)
    buffer_load_dwordx4 v2, s[32:35], s47 offen offset:0 nt lds
    s_waitcnt vmcnt(23)
    buffer_load_dwordx4 v3, s[32:35], s47 offen offset:1024 nt lds
    s_waitcnt vmcnt(23)
    buffer_load_dwordx4 v4, s[32:35], s47 offen offset:2048 nt lds
    s_waitcnt vmcnt(23)
    s_add_u32 s49, s49, 1
    v_mov_b32 v14, s49
    ds_write_b32 v12, v14
    buffer_load_dwordx4 v5, s[32:35], s47 offen offset:3072 nt lds
    v_readfirstlane_b32 s53, v27
    s_nop 0
    s_and_b32 s55, s53, 7
    s_lshr_b32 s57, s53, 3
    s_lshl_b32 s46, s55, 7
    s_add_u32 s46, s46, s57
    s_add_u32 s46, s46, 120
    s_lshl_b32 s46, s46, 13
    s_cmp_lt_u32 s53, 64
    s_cbranch_scc0 L_ld_kover
    s_mov_b32 s59, s53
    s_mov_b64 exec, 1
    global_atomic_add v27, v25, v26, s[26:27] sc0 sc1
    s_mov_b64 exec, -1
    s_add_u32 s50, s50, 1
    s_add_u32 s47, s46, 4096
    s_add_u32 s48, s48, 8192
    s_cmp_ge_u32 s48, 131072
    s_cselect_b32 s48, 0, s48
    s_sub_u32 s52, s50, 15
L_ld_free5:
    s_sub_u32 s89, s89, 1
    s_cbranch_scc1 L_end
    s_waitcnt lgkmcnt(0)
    v_min3_u32 v20, v16, v17, v18
    v_min_u32 v20, v20, v19
    s_nop 0
    v_readfirstlane_b32 s51, v20
    ds_read_b128 v[16:19], v13
    s_cmp_ge_i32 s51, s52
    s_nop 2
    s_cbranch_scc0 L_ld_free5
    s_lshr_b32 s53, s48, 11
    s_add_u32 s53, s53, 147584
    v_mov_b32 v21, s53
    v_mov_b32 v22, s59
    ds_write_b32 v21, v22
    s_add_u32 m0, s48, 0
    s_waitcnt vmcnt(23)
    buffer_load_dwordx4 v2, s[32:35], s46 offen offset:0 nt lds
    s_waitcnt vmcnt(23)
    buffer_load_dwordx4 v3, s[32:35], s46 offen offset:1024 nt lds
    s_waitcnt vmcnt(23)
    buffer_load_dwordx4 v4, s[32:35], s46 offen offset:2048 nt lds
    s_waitcnt vmcnt(23)
    buffer_load_dwordx4 v5, s[32:35], s46 offen offset:3072 nt lds
    s_add_u32 m0, s48, 4096
    s_waitcnt vmcnt(23)
    buffer_load_dwordx4 v2, s[32:35], s47 offen offset:0 nt lds
    s_waitcnt vmcnt(23)
    buffer_load_dwordx4 v3, s[32:35], s47 offen offset:1024 nt lds
    s_waitcnt vmcnt(23)
    buffer_load_dwordx4 v4, s[32:35], s47 offen offset:2048 nt lds
    s_waitcnt vmcnt(23)
    s_add_u32 s49, s49, 1
    v_mov_b32 v14, s49
    ds_write_b32 v12, v14
    buffer_load_dwordx4 v5, s[32:35], s47 offen offset:3072 nt lds
    v_readfirstlane_b32 s53, v29
    s_nop 0
    s_and_b32 s55, s53, 7
    s_lshr_b32 s57, s53, 3
    s_lshl_b32 s46, s55, 7
    s_add_u32 s46, s46, s57
    s_add_u32 s46, s46, 120
    s_lshl_b32 s46, s46, 13
    s_cmp_lt_u32 s53, 64
    s_cbranch_scc0 L_ld_kover
    s_mov_b32 s59, s53
    s_mov_b64 exec, 1
    global_atomic_add v29, v25, v26, s[26:27] sc0 sc1
    s_mov_b64 exec, -1
    s_add_u32 s50, s50, 1
    s_add_u32 s47, s46, 4096
    s_add_u32 s48, s48, 8192
    s_cmp_ge_u32 s48, 131072
    s_cselect_b32 s48, 0, s48
    s_sub_u32 s52, s50, 15
L_ld_free6:
    s_sub_u32 s89, s89, 1
    s_cbranch_scc1 L_end
    s_waitcnt lgkmcnt(0)
    v_min3_u32 v20, v16, v17, v18
    v_min_u32 v20, v20, v19
    s_nop 0
    v_readfirstlane_b32 s51, v20
    ds_read_b128 v[16:19], v13
    s_cmp_ge_i32 s51, s52
    s_nop 2
    s_cbranch_scc0 L_ld_free6
    s_lshr_b32 s53, s48, 11
    s_add_u32 s53, s53, 147584
    v_mov_b32 v21, s53
    v_mov_b32 v22, s59
    ds_write_b32 v21, v22
    s_add_u32 m0, s48, 0
    s_waitcnt vmcnt(23)
    buffer_load_dwordx4 v2, s[32:35], s46 offen offset:0 nt lds
    s_waitcnt vmcnt(23)
    buffer_load_dwordx4 v3, s[32:35], s46 offen offset:1024 nt lds
    s_waitcnt vmcnt(23)
    buffer_load_dwordx4 v4, s[32:35], s46 offen offset:2048 nt lds
    s_waitcnt vmcnt(23)
    buffer_load_dwordx4 v5, s[32:35], s46 offen offset:3072 nt lds
    s_add_u32 m0, s48, 4096
    s_waitcnt vmcnt(23)
    buffer_load_dwordx4 v2, s[32:35], s47 offen offset:0 nt lds
    s_waitcnt vmcnt(23)
    buffer_load_dwordx4 v3, s[32:35], s47 offen offset:1024 nt lds
    s_waitcnt vmcnt(23)
    buffer_load_dwordx4 v4, s[32:35], s47 offen offset:2048 nt lds
    s_waitcnt vmcnt(23)
    s_add_u32 s49, s49, 1
    v_mov_b32 v14, s49
    ds_write_b32 v12, v14
    buffer_load_dwordx4 v5, s[32:35], s47 offen offset:3072 nt lds
    s_branch L_ld_kdyn
L_ld_kover:
    s_add_u32 s56, s50, 1
    v_mov_b32 v14, s56
    ds_write_b32 v12, v14 offset:4
    s_mul_i32 s46, s30, 1048576
    s_sub_u32 s46, s46, 8192
    s_add_u32 s58, s56, 116
L_ld_v:
    s_add_u32 s50, s50, 1
    s_add_u32 s46, s46, 8192
    s_add_u32 s47, s46, 4096
    s_add_u32 s48, s48, 8192
    s_cmp_ge_u32 s48, 131072
    s_cselect_b32 s48, 0, s48
    s_sub_u32 s52, s50, 15
L_ld_free7:
    s_sub_u32 s89, s89, 1
    s_cbranch_scc1 L_end
    s_waitcnt lgkmcnt(0)
    v_min3_u32 v20, v16, v17, v18
    v_min_u32 v20, v20, v19
    s_nop 0
    v_readfirstlane_b32 s51, v20
    ds_read_b128 v[16:19], v13
    s_cmp_ge_i32 s51, s52
    s_nop 2
    s_cbranch_scc0 L_ld_free7
    s_add_u32 m0, s48, 0
    s_waitcnt vmcnt(19)
    buffer_load_dwordx4 v6, s[36:39], s46 offen offset:0 nt lds
    s_waitcnt vmcnt(19)
    buffer_load_dwordx4 v7, s[36:39], s46 offen offset:1024 nt lds
    s_waitcnt vmcnt(19)
    buffer_load_dwordx4 v6, s[36:39], s46 offen offset:2048 nt lds
    s_waitcnt vmcnt(19)
    buffer_load_dwordx4 v7, s[36:39], s46 offen offset:3072 nt lds
    s_add_u32 m0, s48, 4096
    s_waitcnt vmcnt(19)
    buffer_load_dwordx4 v6, s[36:39], s47 offen offset:0 nt lds
    s_waitcnt vmcnt(19)
    buffer_load_dwordx4 v7, s[36:39], s47 offen offset:1024 nt lds
    s_waitcnt vmcnt(19)
    buffer_load_dwordx4 v6, s[36:39], s47 offen offset:2048 nt lds
    s_waitcnt vmcnt(19)
    s_add_u32 s49, s49, 1
    v_mov_b32 v14, s49
    ds_write_b32 v12, v14
    buffer_load_dwordx4 v7, s[36:39], s47 offen offset:3072 nt lds
    s_cmp_lt_u32 s50, s58
    s_cbranch_scc1 L_ld_v
    v_add_u32 v25, 128, v25
    s_mul_i32 s53, s29, 4096
    s_add_u32 s53, s53, 1048576
    s_add_u32 s40, s26, s53
    s_addc_u32 s41, s27, 0
    s_and_b32 s41, s41, 0xffff
    s_mov_b32 s42, 4096
    s_mov_b32 s43, 0x20000
    v_lshlrev_b32 v28, 2, v1
    v_mov_b32 v30, 147512
    s_mov_b64 exec, 1
    global_atomic_add v24, v25, v26, s[26:27] sc0 sc1
    s_mov_b64 exec, -1
    s_add_u32 s50, s50, 1
    s_add_u32 s46, s46, 8192
    s_add_u32 s47, s46, 4096
    s_add_u32 s48, s48, 8192
    s_cmp_ge_u32 s48, 131072
    s_cselect_b32 s48, 0, s48
    s_sub_u32 s52, s50, 15
L_ld_free8:
    s_sub_u32 s89, s89, 1
    s_cbranch_scc1 L_end
    s_waitcnt lgkmcnt(0)
    v_min3_u32 v20, v16, v17, v18
    v_min_u32 v20, v20, v19
    s_nop 0
    v_readfirstlane_b32 s51, v20
    ds_read_b128 v[16:19], v13
    s_cmp_ge_i32 s51, s52
    s_nop 2
    s_cbranch_scc0 L_ld_free8
    s_add_u32 m0, s48, 0
    s_waitcnt vmcnt(23)
    buffer_load_dwordx4 v6, s[36:39], s46 offen offset:0 nt lds
    s_waitcnt vmcnt(23)
    buffer_load_dwordx4 v7, s[36:39], s46 offen offset:1024 nt lds
    s_waitcnt vmcnt(23)
    buffer_load_dwordx4 v6, s[36:39], s46 offen offset:2048 nt lds
    s_waitcnt vmcnt(23)
    buffer_load_dwordx4 v7, s[36:39], s46 offen offset:3072 nt lds
    s_add_u32 m0, s48, 4096
    s_waitcnt vmcnt(23)
    buffer_load_dwordx4 v6, s[36:39], s47 offen offset:0 nt lds
    s_waitcnt vmcnt(23)
    buffer_load_dwordx4 v7, s[36:39], s47 offen offset:1024 nt lds
    s_waitcnt vmcnt(23)
    buffer_load_dwordx4 v6, s[36:39], s47 offen offset:2048 nt lds
    s_waitcnt vmcnt(23)
    s_add_u32 s49, s49, 1
    v_mov_b32 v14, s49
    ds_write_b32 v12, v14
    buffer_load_dwordx4 v7, s[36:39], s47 offen offset:3072 nt lds
    s_mov_b64 exec, 1
    global_atomic_add v27, v25, v26, s[26:27] sc0 sc1
    s_mov_b64 exec, -1
    s_add_u32 s50, s50, 1
    s_add_u32 s46, s46, 8192
    s_add_u32 s47, s46, 4096
    s_add_u32 s48, s48, 8192
    s_cmp_ge_u32 s48, 131072
    s_cselect_b32 s48, 0, s48
    s_sub_u32 s52, s50, 15
L_ld_free9:
    s_sub_u32 s89, s89, 1
    s_cbranch_scc1 L_end
    s_waitcnt lgkmcnt(0)
    v_min3_u32 v20, v16, v17, v18
    v_min_u32 v20, v20, v19
    s_nop 0
    v_readfirstlane_b32 s51, v20
    ds_read_b128 v[16:19], v13
    s_cmp_ge_i32 s51, s52
    s_nop 2
    s_cbranch_scc0 L_ld_free9
    s_add_u32 m0, s48, 0
    s_waitcnt vmcnt(23)
    buffer_load_dwordx4 v6, s[36:39], s46 offen offset:0 nt lds
    s_waitcnt vmcnt(23)
    buffer_load_dwordx4 v7, s[36:39], s46 offen offset:1024 nt lds
    s_waitcnt vmcnt(23)
    buffer_load_dwordx4 v6, s[36:39], s46 offen offset:2048 nt lds
    s_waitcnt vmcnt(23)
    buffer_load_dwordx4 v7, s[36:39], s46 offen offset:3072 nt lds
    s_add_u32 m0, s48, 4096
    s_waitcnt vmcnt(23)
    buffer_load_dwordx4 v6, s[36:39], s47 offen offset:0 nt lds
    s_waitcnt vmcnt(23)
    buffer_load_dwordx4 v7, s[36:39], s47 offen offset:1024 nt lds
    s_waitcnt vmcnt(23)
    buffer_load_dwordx4 v6, s[36:39], s47 offen offset:2048 nt lds
    s_waitcnt vmcnt(23)
    s_add_u32 s49, s49, 1
    v_mov_b32 v14, s49
    ds_write_b32 v12, v14
    buffer_load_dwordx4 v7, s[36:39], s47 offen offset:3072 nt lds
    s_mov_b64 exec, 1
    global_atomic_add v29, v25, v26, s[26:27] sc0 sc1
    s_mov_b64 exec, -1
    s_add_u32 s50, s50, 1
    s_add_u32 s46, s46, 8192
    s_add_u32 s47, s46, 4096
    s_add_u32 s48, s48, 8192
    s_cmp_ge_u32 s48, 131072
    s_cselect_b32 s48, 0, s48
    s_sub_u32 s52, s50, 15
L_ld_free10:
    s_sub_u32 s89, s89, 1
    s_cbranch_scc1 L_end
    s_waitcnt lgkmcnt(0)
    v_min3_u32 v20, v16, v17, v18
    v_min_u32 v20, v20, v19
    s_nop 0
    v_readfirstlane_b32 s51, v20
    ds_read_b128 v[16:19], v13
    s_cmp_ge_i32 s51, s52
    s_nop 2
    s_cbranch_scc0 L_ld_free10
    s_add_u32 m0, s48, 0
    s_waitcnt vmcnt(23)
    buffer_load_dwordx4 v6, s[36:39], s46 offen offset:0 nt lds
    s_waitcnt vmcnt(23)
    buffer_load_dwordx4 v7, s[36:39], s46 offen offset:1024 nt lds
    s_waitcnt vmcnt(23)
    buffer_load_dwordx4 v6, s[36:39], s46 offen offset:2048 nt lds
    s_waitcnt vmcnt(23)
    buffer_load_dwordx4 v7, s[36:39], s46 offen offset:3072 nt lds
    s_add_u32 m0, s48, 4096
    s_waitcnt vmcnt(23)
    buffer_load_dwordx4 v6, s[36:39], s47 offen offset:0 nt lds
    s_waitcnt vmcnt(23)
    buffer_load_dwordx4 v7, s[36:39], s47 offen offset:1024 nt lds
    s_waitcnt vmcnt(23)
    buffer_load_dwordx4 v6, s[36:39], s47 offen offset:2048 nt lds
    s_waitcnt vmcnt(23)
    s_add_u32 s49, s49, 1
    v_mov_b32 v14, s49
    ds_write_b32 v12, v14
    buffer_load_dwordx4 v7, s[36:39], s47 offen offset:3072 nt lds
L_ld_kall:
    s_sub_u32 s89, s89, 1
    s_cbranch_scc1 L_end
    ds_read_b32 v31, v30
    s_waitcnt lgkmcnt(0)
    v_readfirstlane_b32 s53, v31
    s_nop 0
    s_cmp_lg_u32 s53, 0
    s_nop 2
    s_cbranch_scc0 L_ld_kall
    ds_read_b128 v[16:19], v13
L_ld_vdyn:
    v_readfirstlane_b32 s53, v24
    s_nop 0
    s_and_b32 s55, s53, 7
    s_lshr_b32 s57, s53, 3
    s_lshl_b32 s46, s55, 7
    s_add_u32 s46, s46, s57
    s_add_u32 s46, s46, 120
    s_lshl_b32 s46, s46, 13
    s_cmp_lt_u32 s53, 64
    s_cbranch_scc0 L_ld_pover
    s_mov_b32 s59, s53
    s_mov_b64 exec, 1
    global_atomic_add v24, v25, v26, s[26:27] sc0 sc1
    s_mov_b64 exec, -1
    s_add_u32 s50, s50, 1
    s_add_u32 s47, s46, 4096
    s_add_u32 s48, s48, 8192
    s_cmp_ge_u32 s48, 131072
    s_cselect_b32 s48, 0, s48
    s_sub_u32 s52, s50, 15
L_ld_free11:
    s_sub_u32 s89, s89, 1
    s_cbranch_scc1 L_end
    s_waitcnt lgkmcnt(0)
    v_min3_u32 v20, v16, v17, v18
    v_min_u32 v20, v20, v19
    s_nop 0
    v_readfirstlane_b32 s51, v20
    ds_read_b128 v[16:19], v13
    s_cmp_ge_i32 s51, s52
    s_nop 2
    s_cbranch_scc0 L_ld_free11
    s_lshr_b32 s53, s48, 7
    s_add_u32 m0, s53, 161088
    s_lshl_b32 s59, s59, 6
    s_mov_b64 exec, 0xffff
    buffer_load_dword v28, s[40:43], s59 offen sc1 lds
    s_mov_b64 exec, -1
    s_add_u32 m0, s48, 0
    s_waitcnt vmcnt(23)
    buffer_load_dwordx4 v6, s[36:39], s46 offen offset:0 nt lds
    s_waitcnt vmcnt(23)
    buffer_load_dwordx4 v7, s[36:39], s46 offen offset:1024 nt lds
    s_waitcnt vmcnt(23)
    buffer_load_dwordx4 v6, s[36:39], s46 offen offset:2048 nt lds
    s_waitcnt vmcnt(23)
    buffer_load_dwordx4 v7, s[36:39], s46 offen offset:3072 nt lds
    s_add_u32 m0, s48, 4096
    s_waitcnt vmcnt(23)
    buffer_load_dwordx4 v6, s[36:39], s47 offen offset:0 nt lds
    s_waitcnt vmcnt(23)
    buffer_load_dwordx4 v7, s[36:39], s47 offen offset:1024 nt lds
    s_waitcnt vmcnt(23)
    buffer_load_dwordx4 v6, s[36:39], s47 offen offset:2048 nt lds
    s_waitcnt vmcnt(23)
    s_add_u32 s49, s49, 1
    v_mov_b32 v14, s49
    ds_write_b32 v12, v14
    buffer_load_dwordx4 v7, s[36:39], s47 offen offset:3072 nt lds
    v_readfirstlane_b32 s53, v27
    s_nop 0
    s_and_b32 s55, s53, 7
    s_lshr_b32 s57, s53, 3
    s_lshl_b32 s46, s55, 7
    s_add_u32 s46, s46, s57
    s_add_u32 s46, s46, 120
    s_lshl_b32 s46, s46, 13
    s_cmp_lt_u32 s53, 64
    s_cbranch_scc0 L_ld_pover
    s_mov_b32 s59, s53
    s_mov_b64 exec, 1
    global_atomic_add v27, v25, v26, s[26:27] sc0 sc1
    s_mov_b64 exec, -1
    s_add_u32 s50, s50, 1
    s_add_u32 s47, s46, 4096
    s_add_u32 s48, s48, 8192
    s_cmp_ge_u32 s48, 131072
    s_cselect_b32 s48, 0, s48
    s_sub_u32 s52, s50, 15
L_ld_free12:
    s_sub_u32 s89, s89, 1
    s_cbranch_scc1 L_end
    s_waitcnt lgkmcnt(0)
    v_min3_u32 v20, v16, v17, v18
    v_min_u32 v20, v20, v19
    s_nop 0
    v_readfirstlane_b32 s51, v20
    ds_read_b128 v[16:19], v13
    s_cmp_ge_i32 s51, s52
    s_nop 2
    s_cbranch_scc0 L_ld_free12
    s_lshr_b32 s53, s48, 7
    s_add_u32 m0, s53, 161088
    s_lshl_b32 s59, s59, 6
    s_mov_b64 exec, 0xffff
    buffer_load_dword v28, s[40:43], s59 offen sc1 lds
    s_mov_b64 exec, -1
    s_add_u32 m0, s48, 0
    s_waitcnt vmcnt(23)
    buffer_load_dwordx4 v6, s[36:39], s46 offen offset:0 nt lds
    s_waitcnt vmcnt(23)
    buffer_load_dwordx4 v7, s[36:39], s46 offen offset:1024 nt lds
    s_waitcnt vmcnt(23)
    buffer_load_dwordx4 v6, s[36:39], s46 offen offset:2048 nt lds
    s_waitcnt vmcnt(23)
    buffer_load_dwordx4 v7, s[36:39], s46 offen offset:3072 nt lds
    s_add_u32 m0, s48, 4096
    s_waitcnt vmcnt(23)
    buffer_load_dwordx4 v6, s[36:39], s47 offen offset:0 nt lds
    s_waitcnt vmcnt(23)
    buffer_load_dwordx4 v7, s[36:39], s47 offen offset:1024 nt lds
    s_waitcnt vmcnt(23)
    buffer_load_dwordx4 v6, s[36:39], s47 offen offset:2048 nt lds
    s_waitcnt vmcnt(23)
    s_add_u32 s49, s49, 1
    v_mov_b32 v14, s49
    ds_write_b32 v12, v14
    buffer_load_dwordx4 v7, s[36:39], s47 offen offset:3072 nt lds
    v_readfirstlane_b32 s53, v29
    s_nop 0
    s_and_b32 s55, s53, 7
    s_lshr_b32 s57, s53, 3
    s_lshl_b32 s46, s55, 7
    s_add_u32 s46, s46, s57
    s_add_u32 s46, s46, 120
    s_lshl_b32 s46, s46, 13
    s_cmp_lt_u32 s53, 64
    s_cbranch_scc0 L_ld_pover
    s_mov_b32 s59, s53
    s_mov_b64 exec, 1
    global_atomic_add v29, v25, v26, s[26:27] sc0 sc1
    s_mov_b64 exec, -1
    s_add_u32 s50, s50, 1
    s_add_u32 s47, s46, 4096
    s_add_u32 s48, s48, 8192
    s_cmp_ge_u32 s48, 131072
    s_cselect_b32 s48, 0, s48
    s_sub_u32 s52, s50, 15
L_ld_free13:
    s_sub_u32 s89, s89, 1
    s_cbranch_scc1 L_end
    s_waitcnt lgkmcnt(0)
    v_min3_u32 v20, v16, v17, v18
    v_min_u32 v20, v20, v19
    s_nop 0
    v_readfirstlane_b32 s51, v20
    ds_read_b128 v[16:19], v13
    s_cmp_ge_i32 s51, s52
    s_nop 2
    s_cbranch_scc0 L_ld_free13
    s_lshr_b32 s53, s48, 7
    s_add_u32 m0, s53, 161088
    s_lshl_b32 s59, s59, 6
    s_mov_b64 exec, 0xffff
    buffer_load_dword v28, s[40:43], s59 offen sc1 lds
    s_mov_b64 exec, -1
    s_add_u32 m0, s48, 0
    s_waitcnt vmcnt(23)
    buffer_load_dwordx4 v6, s[36:39], s46 offen offset:0 nt lds
    s_waitcnt vmcnt(23)
    buffer_load_dwordx4 v7, s[36:39], s46 offen offset:1024 nt lds
    s_waitcnt vmcnt(23)
    buffer_load_dwordx4 v6, s[36:39], s46 offen offset:2048 nt lds
    s_waitcnt vmcnt(23)
    buffer_load_dwordx4 v7, s[36:39], s46 offen offset:3072 nt lds
    s_add_u32 m0, s48, 4096
    s_waitcnt vmcnt(23)
    buffer_load_dwordx4 v6, s[36:39], s47 offen offset:0 nt lds
    s_waitcnt vmcnt(23)
    buffer_load_dwordx4 v7, s[36:39], s47 offen offset:1024 nt lds
    s_waitcnt vmcnt(23)
    buffer_load_dwordx4 v6, s[36:39], s47 offen offset:2048 nt lds
    s_waitcnt vmcnt(23)
    s_add_u32 s49, s49, 1
    v_mov_b32 v14, s49
    ds_write_b32 v12, v14
    buffer_load_dwordx4 v7, s[36:39], s47 offen offset:3072 nt lds
    s_branch L_ld_vdyn
L_ld_pover:
    s_add_u32 s56, s50, 1
    v_mov_b32 v14, s56
    ds_write_b32 v12, v14 offset:8
    s_nop 0
L_ld_over:
    s_waitcnt vmcnt(16)
    s_add_u32 s49, s49, 1
    v_mov_b32 v14, s49
    ds_write_b32 v12, v14
    s_waitcnt vmcnt(8)
    s_add_u32 s49, s49, 1
    v_mov_b32 v14, s49
    ds_write_b32 v12, v14
    s_waitcnt vmcnt(0)
    s_add_u32 s49, s49, 1
    v_mov_b32 v14, s49
    ds_write_b32 v12, v14
    s_waitcnt lgkmcnt(0)
    s_endpgm
L_consumer:
    s_sub_u32 s40, s28, 1
    s_mov_b32 s43, 0xffff0000
    v_lshrrev_b32 v8, 4, v1
    v_and_b32 v9, 15, v1
    s_cmp_eq_u32 s40, 0
    s_nop 0
    s_cbranch_scc1 L_c_q
    s_barrier
    s_branch L_c_qwait
L_c_q:
    s_cmp_eq_u32 s2, 0
    s_cbranch_scc0 L_q_notag
    s_memrealtime s[56:57]
    s_waitcnt lgkmcnt(0)
    s_or_b32 s56, s56, 1
    s_or_b32 s57, s57, 0x40000000
    s_and_b32 s57, s57, 0x7fffffff
    v_mov_b32 v34, s56
    v_mov_b32 v35, s57
    v_mov_b32 v2, 0
    s_mov_b64 exec, 1
    global_store_dwordx2 v2, v[34:35], s[24:25] sc1
    s_mov_b64 exec, -1
L_q_notag:
    v_mov_b32 v2, 0
    global_load_dwordx2 v[34:35], v2, s[24:25] sc1
    s_mov_b32 s32, s10
    s_and_b32 s33, s11, 0xffff
    s_mov_b32 s34, 0x400000
    s_mov_b32 s35, 0x20000
    v_lshlrev_b32 v2, 4, v1
    global_load_dwordx4 v[30:33], v2, s[4:5]
    s_lshl_b32 s41, s30, 6
    v_add_u32 v3, s41, v8
    v_lshlrev_b32 v3, 13, v3
    v_lshlrev_b32 v4, 4, v9
    v_add_u32 v3, v3, v4
    s_lshl_b32 s41, s29, 8
    v_add_u32 v3, s41, v3
    s_mov_b32 s42, 0
    buffer_load_dwordx4 v[40:43], v3, s[32:35], s42 offen nt
    s_mov_b32 s42, 32768
    buffer_load_dwordx4 v[44:47], v3, s[32:35], s42 offen nt
    s_mov_b32 s42, 65536
    buffer_load_dwordx4 v[48:51], v3, s[32:35], s42 offen nt
    s_mov_b32 s42, 98304
    buffer_load_dwordx4 v[52:55], v3, s[32:35], s42 offen nt
    s_mov_b32 s42, 131072
    buffer_load_dwordx4 v[56:59], v3, s[32:35], s42 offen nt
    s_mov_b32 s42, 163840
    buffer_load_dwordx4 v[60:63], v3, s[32:35], s42 offen nt
    s_mov_b32 s42, 196608
    buffer_load_dwordx4 v[64:67], v3, s[32:35], s42 offen nt
    s_mov_b32 s42, 229376
    buffer_load_dwordx4 v[68:71], v3, s[32:35], s42 offen nt
    s_mov_b32 s42, 262144
    buffer_load_dwordx4 v[72:75], v3, s[32:35], s42 offen nt
    s_mov_b32 s42, 294912
    buffer_load_dwordx4 v[76:79], v3, s[32:35], s42 offen nt
    s_mov_b32 s42, 327680
    buffer_load_dwordx4 v[80:83], v3, s[32:35], s42 offen nt
    s_mov_b32 s42, 360448
    buffer_load_dwordx4 v[84:87], v3, s[32:35], s42 offen nt
    s_mov_b32 s42, 393216
    buffer_load_dwordx4 v[88:91], v3, s[32:35], s42 offen nt
    s_mov_b32 s42, 425984
    buffer_load_dwordx4 v[92:95], v3, s[32:35], s42 offen nt
    s_mov_b32 s42, 458752
    buffer_load_dwordx4 v[96:99], v3, s[32:35], s42 offen nt
    s_mov_b32 s42, 491520
    buffer_load_dwordx4 v[100:103], v3, s[32:35], s42 offen nt
    s_barrier
    s_waitcnt vmcnt(16)
    v_lshlrev_b32 v10, 16, v30
    v_and_b32 v11, s43, v30
    v_lshlrev_b32 v12, 16, v31
    v_and_b32 v13, s43, v31
    v_lshlrev_b32 v14, 16, v32
    v_and_b32 v15, s43, v32
    v_lshlrev_b32 v16, 16, v33
    v_and_b32 v17, s43, v33
    v_add_f32 v4, v10, v11
    v_add_f32 v4, v4, v12
    v_add_f32 v4, v4, v13
    v_add_f32 v4, v4, v14
    v_add_f32 v4, v4, v15
    v_add_f32 v4, v4, v16
    v_add_f32 v4, v4, v17
    s_nop 1
    v_add_f32_dpp v4, v4, v4 row_ror:8 row_mask:0xf bank_mask:0xf
    s_nop 1
    v_add_f32_dpp v4, v4, v4 row_ror:4 row_mask:0xf bank_mask:0xf
    s_nop 1
    v_add_f32_dpp v4, v4, v4 row_ror:2 row_mask:0xf bank_mask:0xf
    s_nop 1
    v_add_f32_dpp v4, v4, v4 row_ror:1 row_mask:0xf bank_mask:0xf
    v_mov_b32 v5, v4
    s_nop 1
    v_permlane16_swap_b32 v4, v5
    v_add_f32 v4, v4, v5
    v_mov_b32 v5, v4
    s_nop 1
    v_permlane32_swap_b32 v4, v5
    v_add_f32 v4, v4, v5
    v_mul_f32 v4, 0x3b000000, v4
    v_cvt_pk_bf16_f32 v6, v4, v4
    v_and_b32 v6, s43, v6
    v_sub_f32 v5, v10, v4
    v_mul_f32 v7, v5, v5
    v_sub_f32 v5, v11, v4
    v_fmac_f32 v7, v5, v5
    v_sub_f32 v5, v12, v4
    v_fmac_f32 v7, v5, v5
    v_sub_f32 v5, v13, v4
    v_fmac_f32 v7, v5, v5
    v_sub_f32 v5, v14, v4
    v_fmac_f32 v7, v5, v5
    v_sub_f32 v5, v15, v4
    v_fmac_f32 v7, v5, v5
    v_sub_f32 v5, v16, v4
    v_fmac_f32 v7, v5, v5
    v_sub_f32 v5, v17, v4
    v_fmac_f32 v7, v5, v5
    s_nop 1
    v_add_f32_dpp v7, v7, v7 row_ror:8 row_mask:0xf bank_mask:0xf
    s_nop 1
    v_add_f32_dpp v7, v7, v7 row_ror:4 row_mask:0xf bank_mask:0xf
    s_nop 1
    v_add_f32_dpp v7, v7, v7 row_ror:2 row_mask:0xf bank_mask:0xf
    s_nop 1
    v_add_f32_dpp v7, v7, v7 row_ror:1 row_mask:0xf bank_mask:0xf
    v_mov_b32 v5, v7
    s_nop 1
    v_permlane16_swap_b32 v7, v5
    v_add_f32 v7, v7, v5
    v_mov_b32 v5, v7
    s_nop 1
    v_permlane32_swap_b32 v7, v5
    v_add_f32 v7, v7, v5
    v_mul_f32 v7, 0x3b000000, v7
    v_cvt_pk_bf16_f32 v7, v7, v7
    v_and_b32 v7, s43, v7
    v_add_f32 v7, 0x3727c5ac, v7
    v_cvt_pk_bf16_f32 v7, v7, v7
    v_and_b32 v7, s43, v7
    v_sqrt_f32 v7, v7
    s_nop 0
    v_cvt_pk_bf16_f32 v7, v7, v7
    v_and_b32 v7, s43, v7
    v_rcp_f32 v7, v7
    v_sub_f32 v10, v10, v6
    v_sub_f32 v11, v11, v6
    v_cvt_pk_bf16_f32 v5, v10, v11
    v_lshlrev_b32 v10, 16, v5
    v_and_b32 v11, s43, v5
    v_mul_f32 v10, v10, v7
    v_mul_f32 v11, v11, v7
    v_sub_f32 v12, v12, v6
    v_sub_f32 v13, v13, v6
    v_cvt_pk_bf16_f32 v5, v12, v13
    v_lshlrev_b32 v12, 16, v5
    v_and_b32 v13, s43, v5
    v_mul_f32 v12, v12, v7
    v_mul_f32 v13, v13, v7
    v_sub_f32 v14, v14, v6
    v_sub_f32 v15, v15, v6
    v_cvt_pk_bf16_f32 v5, v14, v15
    v_lshlrev_b32 v14, 16, v5
    v_and_b32 v15, s43, v5
    v_mul_f32 v14, v14, v7
    v_mul_f32 v15, v15, v7
    v_sub_f32 v16, v16, v6
    v_sub_f32 v17, v17, v6
    v_cvt_pk_bf16_f32 v5, v16, v17
    v_lshlrev_b32 v16, 16, v5
    v_and_b32 v17, s43, v5
    v_mul_f32 v16, v16, v7
    v_mul_f32 v17, v17, v7
    v_cvt_pk_bf16_f32 v18, v10, v10
    v_cvt_pk_bf16_f32 v19, v11, v11
    v_cvt_pk_bf16_f32 v20, v12, v12
    v_cvt_pk_bf16_f32 v21, v13, v13
    v_cvt_pk_bf16_f32 v22, v14, v14
    v_cvt_pk_bf16_f32 v23, v15, v15
    v_cvt_pk_bf16_f32 v24, v16, v16
    v_cvt_pk_bf16_f32 v25, v17, v17
    v_lshrrev_b32 v4, 3, v1
    v_lshlrev_b32 v4, 8, v4
    v_and_b32 v5, 7, v1
    v_lshlrev_b32 v5, 3, v5
    v_add_u32 v4, v4, v5
    v_add_u32 v4, 147712, v4
    v_mov_b32 v26, v18
    v_mov_b32 v27, v22
    ds_write_b64 v4, v[26:27] offset:0
    v_mov_b32 v26, v19
    v_mov_b32 v27, v23
    ds_write_b64 v4, v[26:27] offset:64
    v_mov_b32 v26, v20
    v_mov_b32 v27, v24
    ds_write_b64 v4, v[26:27] offset:128
    v_mov_b32 v26, v21
    v_mov_b32 v27, v25
    ds_write_b64 v4, v[26:27] offset:192
    v_and_b32 v5, 1, v9
    v_mov_b32 v6, 0xffff
    v_mov_b32 v7, s43
    v_cmp_eq_u32 vcc, 1, v5
    s_nop 1
    v_cndmask_b32 v5, v6, v7, vcc
    v_lshrrev_b32 v6, 1, v9
    v_cmp_eq_u32 vcc, 0, v6
    s_nop 1
    v_cndmask_b32 v10, 0, v5, vcc
    v_cmp_eq_u32 vcc, 1, v6
    s_nop 1
    v_cndmask_b32 v11, 0, v5, vcc
    v_cmp_eq_u32 vcc, 2, v6
    s_nop 1
    v_cndmask_b32 v12, 0, v5, vcc
    v_cmp_eq_u32 vcc, 3, v6
    s_nop 1
    v_cndmask_b32 v13, 0, v5, vcc
    s_lshl_b32 s41, s30, 8
    s_add_u32 s41, s41, 147712
    v_lshlrev_b32 v4, 6, v8
    v_add_u32 v4, s41, v4
    s_waitcnt lgkmcnt(0)
    ds_read_b128 v[104:107], v4
    ds_read_b128 v[108:111], v4 offset:16
    ds_read_b128 v[112:115], v4 offset:32
    ds_read_b128 v[116:119], v4 offset:48
    s_waitcnt lgkmcnt(0)
    v_and_b32 v18, v104, v10
    v_and_b32 v19, v104, v11
    v_and_b32 v20, v104, v12
    v_and_b32 v21, v104, v13
    s_waitcnt vmcnt(15)
    s_nop 0
    v_mfma_f32_16x16x32_bf16 v[26:29], v[40:43], v[18:21], 0
    v_and_b32 v22, v105, v10
    v_and_b32 v23, v105, v11
    v_and_b32 v24, v105, v12
    v_and_b32 v25, v105, v13
    s_waitcnt vmcnt(14)
    s_nop 0
    v_mfma_f32_16x16x32_bf16 v[26:29], v[44:47], v[22:25], v[26:29]
    v_and_b32 v18, v106, v10
    v_and_b32 v19, v106, v11
    v_and_b32 v20, v106, v12
    v_and_b32 v21, v106, v13
    s_waitcnt vmcnt(13)
    s_nop 0
    v_mfma_f32_16x16x32_bf16 v[26:29], v[48:51], v[18:21], v[26:29]
    v_and_b32 v22, v107, v10
    v_and_b32 v23, v107, v11
    v_and_b32 v24, v107, v12
    v_and_b32 v25, v107, v13
    s_waitcnt vmcnt(12)
    s_nop 0
    v_mfma_f32_16x16x32_bf16 v[26:29], v[52:55], v[22:25], v[26:29]
    v_and_b32 v18, v108, v10
    v_and_b32 v19, v108, v11
    v_and_b32 v20, v108, v12
    v_and_b32 v21, v108, v13
    s_waitcnt vmcnt(11)
    s_nop 0
    v_mfma_f32_16x16x32_bf16 v[26:29], v[56:59], v[18:21], v[26:29]
    v_and_b32 v22, v109, v10
    v_and_b32 v23, v109, v11
    v_and_b32 v24, v109, v12
    v_and_b32 v25, v109, v13
    s_waitcnt vmcnt(10)
    s_nop 0
    v_mfma_f32_16x16x32_bf16 v[26:29], v[60:63], v[22:25], v[26:29]
    v_and_b32 v18, v110, v10
    v_and_b32 v19, v110, v11
    v_and_b32 v20, v110, v12
    v_and_b32 v21, v110, v13
    s_waitcnt vmcnt(9)
    s_nop 0
    v_mfma_f32_16x16x32_bf16 v[26:29], v[64:67], v[18:21], v[26:29]
    v_and_b32 v22, v111, v10
    v_and_b32 v23, v111, v11
    v_and_b32 v24, v111, v12
    v_and_b32 v25, v111, v13
    s_waitcnt vmcnt(8)
    s_nop 0
    v_mfma_f32_16x16x32_bf16 v[26:29], v[68:71], v[22:25], v[26:29]
    v_and_b32 v18, v112, v10
    v_and_b32 v19, v112, v11
    v_and_b32 v20, v112, v12
    v_and_b32 v21, v112, v13
    s_waitcnt vmcnt(7)
    s_nop 0
    v_mfma_f32_16x16x32_bf16 v[26:29], v[72:75], v[18:21], v[26:29]
    v_and_b32 v22, v113, v10
    v_and_b32 v23, v113, v11
    v_and_b32 v24, v113, v12
    v_and_b32 v25, v113, v13
    s_waitcnt vmcnt(6)
    s_nop 0
    v_mfma_f32_16x16x32_bf16 v[26:29], v[76:79], v[22:25], v[26:29]
    v_and_b32 v18, v114, v10
    v_and_b32 v19, v114, v11
    v_and_b32 v20, v114, v12
    v_and_b32 v21, v114, v13
    s_waitcnt vmcnt(5)
    s_nop 0
    v_mfma_f32_16x16x32_bf16 v[26:29], v[80:83], v[18:21], v[26:29]
    v_and_b32 v22, v115, v10
    v_and_b32 v23, v115, v11
    v_and_b32 v24, v115, v12
    v_and_b32 v25, v115, v13
    s_waitcnt vmcnt(4)
    s_nop 0
    v_mfma_f32_16x16x32_bf16 v[26:29], v[84:87], v[22:25], v[26:29]
    v_and_b32 v18, v116, v10
    v_and_b32 v19, v116, v11
    v_and_b32 v20, v116, v12
    v_and_b32 v21, v116, v13
    s_waitcnt vmcnt(3)
    s_nop 0
    v_mfma_f32_16x16x32_bf16 v[26:29], v[88:91], v[18:21], v[26:29]
    v_and_b32 v22, v117, v10
    v_and_b32 v23, v117, v11
    v_and_b32 v24, v117, v12
    v_and_b32 v25, v117, v13
    s_waitcnt vmcnt(2)
    s_nop 0
    v_mfma_f32_16x16x32_bf16 v[26:29], v[92:95], v[22:25], v[26:29]
    v_and_b32 v18, v118, v10
    v_and_b32 v19, v118, v11
    v_and_b32 v20, v118, v12
    v_and_b32 v21, v118, v13
    s_waitcnt vmcnt(1)
    s_nop 0
    v_mfma_f32_16x16x32_bf16 v[26:29], v[96:99], v[18:21], v[26:29]
    v_and_b32 v22, v119, v10
    v_and_b32 v23, v119, v11
    v_and_b32 v24, v119, v12
    v_and_b32 v25, v119, v13
    s_waitcnt vmcnt(0)
    s_nop 0
    v_mfma_f32_16x16x32_bf16 v[26:29], v[100:103], v[22:25], v[26:29]
    v_readfirstlane_b32 s56, v34
    v_readfirstlane_b32 s57, v35
    s_cmp_lg_u32 s56, 0
    s_nop 4
    s_cbranch_scc1 L_q_havetag
L_q_tagpoll:
    s_sub_u32 s89, s89, 1
    s_cbranch_scc1 L_end
    v_mov_b32 v2, 0
    global_load_dwordx2 v[34:35], v2, s[24:25] sc1
    s_waitcnt vmcnt(0)
    v_readfirstlane_b32 s56, v34
    v_readfirstlane_b32 s57, v35
    s_cmp_lg_u32 s56, 0
    s_nop 3
    s_cbranch_scc1 L_q_havetag
    s_sleep 2
    s_branch L_q_tagpoll
L_q_havetag:
    v_mov_b32 v5, 147492
    s_nop 1
L_q_clr:
    s_sub_u32 s89, s89, 1
    s_cbranch_scc1 L_end
    ds_read_b32 v6, v5
    s_waitcnt lgkmcnt(0)
    v_readfirstlane_b32 s42, v6
    s_nop 0
    s_cmp_lg_u32 s42, 0
    s_nop 2
    s_cbranch_scc1 L_q_clr_ok
    s_sleep 1
    s_branch L_q_clr
L_q_clr_ok:
    v_mov_b32_dpp v14, v28 row_ror:8 row_mask:0xf bank_mask:0xf
    v_mov_b32_dpp v16, v29 row_ror:8 row_mask:0xf bank_mask:0xf
    v_cmp_gt_u32 vcc, 8, v9
    v_mov_b32 v11, s56
    v_mov_b32 v13, s57
    v_cndmask_b32 v10, v14, v26, vcc
    v_cndmask_b32 v12, v16, v27, vcc
    v_mov_b32 v18, s56
    v_mov_b32 v19, s57
    v_mov_b32 v6, 147504
    ds_write_b64 v6, v[18:19]
    s_lshl_b32 s41, s3, 10
    s_add_u32 s41, s41, 294912
    v_and_b32 v4, 7, v9
    v_lshlrev_b32 v4, 1, v4
    v_lshrrev_b32 v5, 3, v9
    v_add_u32 v4, v4, v5
    v_lshlrev_b32 v5, 4, v8
    v_add_u32 v4, v4, v5
    v_lshlrev_b32 v4, 4, v4
    v_add_u32 v4, s41, v4
    global_store_dwordx4 v4, v[10:13], s[26:27] sc1
    v_mov_b32 v6, 147516
    v_mov_b32 v7, 1
    ds_write_b32 v6, v7
    s_mov_b64 exec, 1
    s_lshl_b32 s41, s3, 3
    s_add_u32 s41, s41, 573440
    v_mov_b32 v4, s41
    global_store_dwordx2 v4, v[18:19], s[26:27] sc1
    s_mov_b64 exec, -1
    s_lshl_b32 s41, s29, 13
    s_add_u32 s41, s41, 294912
    v_lshlrev_b32 v4, 4, v1
    v_add_u32 v4, s41, v4
    v_add_u32 v5, 4096, v4
    s_nop 1
L_q_poll:
    s_sub_u32 s89, s89, 1
    s_cbranch_scc1 L_end
    global_load_dwordx4 v[40:43], v4, s[26:27] offset:0 sc1
    global_load_dwordx4 v[44:47], v4, s[26:27] offset:1024 sc1
    global_load_dwordx4 v[48:51], v4, s[26:27] offset:2048 sc1
    global_load_dwordx4 v[52:55], v4, s[26:27] offset:3072 sc1
    global_load_dwordx4 v[56:59], v5, s[26:27] offset:0 sc1
    global_load_dwordx4 v[60:63], v5, s[26:27] offset:1024 sc1
    global_load_dwordx4 v[64:67], v5, s[26:27] offset:2048 sc1
    global_load_dwordx4 v[68:71], v5, s[26:27] offset:3072 sc1
    s_waitcnt vmcnt(0)
    v_xor_b32 v6, s56, v41
    v_xor_b32 v7, s57, v43
    v_or_b32 v6, v6, v7
    v_xor_b32 v7, s56, v45
    v_or_b32 v6, v6, v7
    v_xor_b32 v7, s57, v47
    v_or_b32 v6, v6, v7
    v_xor_b32 v7, s56, v49
    v_or_b32 v6, v6, v7
    v_xor_b32 v7, s57, v51
    v_or_b32 v6, v6, v7
    v_xor_b32 v7, s56, v53
    v_or_b32 v6, v6, v7
    v_xor_b32 v7, s57, v55
    v_or_b32 v6, v6, v7
    v_xor_b32 v7, s56, v57
    v_or_b32 v6, v6, v7
    v_xor_b32 v7, s57, v59
    v_or_b32 v6, v6, v7
    v_xor_b32 v7, s56, v61
    v_or_b32 v6, v6, v7
    v_xor_b32 v7, s57, v63
    v_or_b32 v6, v6, v7
    v_xor_b32 v7, s56, v65
    v_or_b32 v6, v6, v7
    v_xor_b32 v7, s57, v67
    v_or_b32 v6, v6, v7
    v_xor_b32 v7, s56, v69
    v_or_b32 v6, v6, v7
    v_xor_b32 v7, s57, v71
    v_or_b32 v6, v6, v7
    v_cmp_ne_u32 vcc, 0, v6
    s_nop 4
    s_cbranch_vccz L_q_seen
    s_sleep 2
    s_branch L_q_poll
L_q_seen:
    v_add_f32 v40, v40, v44
    v_add_f32 v48, v48, v52
    v_add_f32 v56, v56, v60
    v_add_f32 v64, v64, v68
    v_add_f32 v42, v42, v46
    v_add_f32 v50, v50, v54
    v_add_f32 v58, v58, v62
    v_add_f32 v66, v66, v70
    v_add_f32 v40, v40, v48
    v_add_f32 v56, v56, v64
    v_add_f32 v42, v42, v50
    v_add_f32 v58, v58, v66
    v_add_f32 v40, v40, v56
    v_add_f32 v42, v42, v58
    v_cvt_pk_bf16_f32 v10, v40, v42
    v_lshrrev_b32 v11, 16, v10
    v_lshrrev_b32 v5, 1, v9
    v_and_b32 v6, 1, v1
    v_lshlrev_b32 v6, 4, v6
    v_add_u32 v5, v5, v6
    v_lshlrev_b32 v6, 5, v8
    v_add_u32 v5, v5, v6
    v_lshlrev_b32 v5, 1, v5
    v_add_u32 v5, 149760, v5
    ds_write_b16 v5, v10
    ds_write_b16 v5, v11 offset:16
    v_mov_b32 v6, 147500
    v_mov_b32 v7, 1
    s_waitcnt lgkmcnt(0)
    ds_write_b32 v6, v7
L_c_qwait:
    v_mov_b32 v5, 147500
    s_nop 1
L_c_qw:
    s_sub_u32 s89, s89, 1
    s_cbranch_scc1 L_end
    ds_read_b32 v6, v5
    s_waitcnt lgkmcnt(0)
    v_readfirstlane_b32 s42, v6
    s_nop 0
    s_cmp_lg_u32 s42, 0
    s_nop 2
    s_cbranch_scc1 L_c_qw_ok
    s_sleep 1
    s_branch L_c_qw
L_c_qw_ok:
    v_lshlrev_b32 v5, 4, v8
    v_add_u32 v5, 149760, v5
    ds_read_b128 v[40:43], v5
    ds_read_b128 v[44:47], v5 offset:64
    ds_read_b128 v[48:51], v5 offset:128
    ds_read_b128 v[52:55], v5 offset:192
    v_xor_b32 v2, v8, v9
    v_lshlrev_b32 v2, 4, v2
    v_lshlrev_b32 v10, 8, v9
    v_add_u32 v2, v2, v10
    v_lshrrev_b32 v10, 2, v9
    v_and_b32 v11, 3, v9
    v_lshlrev_b32 v12, 2, v8
    v_add_u32 v12, v12, v10
    v_and_b32 v13, 7, v12
    v_lshlrev_b32 v13, 1, v13
    v_lshrrev_b32 v14, 1, v11
    v_xor_b32 v13, v13, v14
    v_lshlrev_b32 v13, 4, v13
    v_and_b32 v14, 1, v11
    v_lshlrev_b32 v14, 3, v14
    v_lshlrev_b32 v3, 8, v12
    v_add_u32 v3, v3, v13
    v_add_u32 v3, v3, v14
    v_mov_b32 v4, 0xff800000
    v_mov_b32 v5, 0
    v_mov_b32 v6, 0
    v_mov_b32 v7, 147456
    s_lshl_b32 s41, s40, 2
    s_add_u32 s41, s41, 147472
    v_mov_b32 v38, s41
    s_mov_b32 s44, 0x3fb8aa3b
    s_mov_b32 s45, 0x3db504f3
    s_mov_b32 s46, s40
    s_lshl_b32 s47, s40, 13
    s_mov_b32 s48, -100
    s_mov_b32 s50, 0x7fffffff
    v_mov_b32 v56, 0
    v_mov_b32 v57, 0
    v_mov_b32 v58, 0
    v_mov_b32 v59, 0
    v_mov_b32 v60, 0
    v_mov_b32 v61, 0
    v_mov_b32 v62, 0
    v_mov_b32 v63, 0
    v_mov_b32 v64, 0
    v_mov_b32 v65, 0
    v_mov_b32 v66, 0
    v_mov_b32 v67, 0
    v_mov_b32 v68, 0
    v_mov_b32 v69, 0
    v_mov_b32 v70, 0
    v_mov_b32 v71, 0
    v_mov_b32 v72, 0
    v_mov_b32 v73, 0
    v_mov_b32 v74, 0
    v_mov_b32 v75, 0
    v_mov_b32 v76, 0
    v_mov_b32 v77, 0
    v_mov_b32 v78, 0
    v_mov_b32 v79, 0
    v_mov_b32 v80, 0
    v_mov_b32 v81, 0
    v_mov_b32 v82, 0
    v_mov_b32 v83, 0
    v_mov_b32 v84, 0
    v_mov_b32 v85, 0
    v_mov_b32 v86, 0
    v_mov_b32 v87, 0
    s_lshl_b32 s41, s40, 9
    s_add_u32 s41, s41, 147712
    v_lshlrev_b32 v120, 2, v9
    v_add_u32 v120, s41, v120
    s_lshl_b32 s41, s40, 3
    s_add_u32 s41, s41, 150016
    v_mov_b32 v121, s41
    v_mov_b32 v122, 147488
    v_mov_b32 v123, 1
    v_lshlrev_b32 v124, 3, v1
    s_mul_i32 s41, s3, 640
    v_add_u32 v125, s41, v124
    v_add_u32 v124, 147712, v124
    v_mov_b32 v126, 150016
    v_mov_b32 v127, 147496
    s_waitcnt lgkmcnt(0)
    v_lshlrev_b32 v39, 4, v8
    v_add_u32 v39, 153408, v39
    s_mov_b32 s60, 0x00010001
    s_mov_b32 s61, 0x00010001
    s_mul_i32 s41, s29, 4096
    s_add_u32 s41, s41, 1048576
    v_lshlrev_b32 v128, 4, v8
    v_add_u32 v128, s41, v128
    v_lshlrev_b32 v129, 4, v8
    v_add_u32 v129, 161088, v129
    s_mov_b32 s52, 0x7fffffff
    s_nop 0
L_c_tile:
    s_cmp_ge_u32 s46, s50
    s_cbranch_scc1 L_c_sw
    s_add_u32 s49, s46, 1
L_c_k_poll:
    s_sub_u32 s89, s89, 1
    s_cbranch_scc1 L_end
    ds_read_b128 v[34:37], v7
    s_waitcnt lgkmcnt(0)
    v_readfirstlane_b32 s48, v34
    v_readfirstlane_b32 s50, v35
    s_nop 0
    s_cmp_ge_u32 s46, s50
    s_nop 2
    s_cbranch_scc1 L_c_sw
    s_cmp_ge_i32 s48, s49
    s_cbranch_scc1 L_c_k_ok
    s_sleep 1
    s_branch L_c_k_poll
L_c_k_ok:
    v_add_u32 v10, s47, v2
    v_xor_b32 v11, 64, v10
    v_xor_b32 v12, 128, v10
    v_xor_b32 v13, 192, v10
    ds_read_b128 v[88:91], v10
    ds_read_b128 v[104:107], v10 offset:4096
    ds_read_b128 v[92:95], v11
    ds_read_b128 v[108:111], v11 offset:4096
    ds_read_b128 v[96:99], v12
    ds_read_b128 v[112:115], v12 offset:4096
    ds_read_b128 v[100:103], v13
    ds_read_b128 v[116:119], v13 offset:4096
    s_lshr_b32 s49, s47, 11
    s_add_u32 s49, s49, 147584
    v_mov_b32 v14, s49
    ds_read_b32 v16, v14
    s_lshl_b32 s51, s46, 6
    s_add_u32 s46, s46, 4
    v_mov_b32 v15, s46
    s_waitcnt lgkmcnt(7)
    v_mfma_f32_16x16x32_bf16 v[18:21], v[88:91], v[40:43], 0
    v_mfma_f32_16x16x32_bf16 v[22:25], v[104:107], v[40:43], 0
    s_waitcnt lgkmcnt(5)
    v_mfma_f32_16x16x32_bf16 v[18:21], v[92:95], v[44:47], v[18:21]
    v_mfma_f32_16x16x32_bf16 v[22:25], v[108:111], v[44:47], v[22:25]
    s_waitcnt lgkmcnt(3)
    v_mfma_f32_16x16x32_bf16 v[18:21], v[96:99], v[48:51], v[18:21]
    v_mfma_f32_16x16x32_bf16 v[22:25], v[112:115], v[48:51], v[22:25]
    s_waitcnt lgkmcnt(0)
    ds_write_b32 v38, v15
    v_mfma_f32_16x16x32_bf16 v[18:21], v[100:103], v[52:55], v[18:21]
    v_mfma_f32_16x16x32_bf16 v[22:25], v[116:119], v[52:55], v[22:25]
    s_add_u32 s47, s47, 32768
    s_cmp_ge_u32 s47, 131072
    s_cselect_b32 s49, 131072, 0
    s_sub_u32 s47, s47, s49
    s_nop 2
    v_cvt_pk_bf16_f32 v30, v18, v19
    v_cvt_pk_bf16_f32 v31, v20, v21
    v_cvt_pk_bf16_f32 v32, v22, v23
    v_cvt_pk_bf16_f32 v33, v24, v25
    v_lshlrev_b32 v18, 16, v30
    v_and_b32 v19, s43, v30
    v_lshlrev_b32 v20, 16, v31
    v_and_b32 v21, s43, v31
    v_lshlrev_b32 v22, 16, v32
    v_and_b32 v23, s43, v32
    v_lshlrev_b32 v24, 16, v33
    v_and_b32 v25, s43, v33
    v_mul_f32 v18, s45, v18
    v_mul_f32 v19, s45, v19
    v_mul_f32 v20, s45, v20
    v_mul_f32 v21, s45, v21
    v_mul_f32 v22, s45, v22
    v_mul_f32 v23, s45, v23
    v_mul_f32 v24, s45, v24
    v_mul_f32 v25, s45, v25
    v_cvt_pk_bf16_f32 v28, v18, v19
    v_cvt_pk_bf16_f32 v29, v20, v21
    v_cvt_pk_bf16_f32 v30, v22, v23
    v_cvt_pk_bf16_f32 v31, v24, v25
    s_cmp_lt_u32 s51, 7680
    s_nop 0
    s_cbranch_scc0 L_c_kpool
    v_add_u32 v14, s51, v39
    s_mov_b64 exec, s[60:61]
    ds_write_b128 v14, v[28:31]
    s_mov_b64 exec, -1
    s_branch L_c_kmax
L_c_kpool:
    v_lshlrev_b32 v16, 6, v16
    v_add_u32 v14, v16, v128
    s_mov_b64 exec, s[60:61]
    global_store_dwordx4 v14, v[28:31], s[26:27] sc1
    s_mov_b64 exec, -1
    s_nop 0
L_c_kmax:
    v_lshlrev_b32 v18, 16, v28
    v_and_b32 v19, s43, v28
    v_lshlrev_b32 v20, 16, v29
    v_and_b32 v21, s43, v29
    v_lshlrev_b32 v22, 16, v30
    v_and_b32 v23, s43, v30
    v_lshlrev_b32 v24, 16, v31
    v_and_b32 v25, s43, v31
    v_max3_f32 v4, v4, v18, v19
    v_max3_f32 v4, v4, v20, v21
    v_max3_f32 v4, v4, v22, v23
    v_max3_f32 v4, v4, v24, v25
    s_nop 1
    s_branch L_c_tile
L_c_sw:
    v_mov_b32 v30, v4
    s_lshl_b32 s41, s40, 2
    s_add_u32 s41, s41, 147520
    v_permlane32_swap_b32 v4, v30
    v_mov_b32 v31, s41
    v_max_f32 v4, v4, v30
    v_mov_b32 v32, 147468
    v_mov_b32 v30, v4
    v_mov_b32 v33, 147520
    s_nop 0
    v_permlane16_swap_b32 v4, v30
    v_max_f32 v4, v4, v30
    ds_write_b32 v31, v4
    s_waitcnt vmcnt(0) lgkmcnt(0)
    ds_add_u32 v32, v123
L_c_sw_wait:
    s_sub_u32 s89, s89, 1
    s_cbranch_scc1 L_end
    ds_read_b32 v30, v32
    ds_read_b128 v[20:23], v33
    s_waitcnt lgkmcnt(0)
    v_readfirstlane_b32 s41, v30
    s_nop 0
    s_cmp_ge_u32 s41, 256
    s_nop 2
    s_cbranch_scc0 L_c_sw_wait
    v_max3_f32 v4, v20, v21, v22
    v_max_f32 v4, v4, v23
    v_mul_f32 v6, s44, v4
    s_add_u32 s51, s50, 120
    s_nop 0
L_c_vtile:
    s_sub_u32 s49, s46, s50
    s_lshl_b32 s49, s49, 6
    v_add_u32 v14, s49, v39
    ds_read_b128 v[28:31], v14
    v_add_u32 v10, s47, v3
    v_xor_b32 v11, 32, v10
    v_xor_b32 v12, 64, v10
    v_xor_b32 v13, 96, v10
    v_xor_b32 v14, 128, v10
    v_xor_b32 v15, 160, v10
    v_xor_b32 v16, 192, v10
    v_xor_b32 v17, 224, v10
    s_waitcnt lgkmcnt(0)
    v_lshlrev_b32 v18, 16, v28
    v_and_b32 v19, s43, v28
    v_lshlrev_b32 v20, 16, v29
    v_and_b32 v21, s43, v29
    v_lshlrev_b32 v22, 16, v30
    v_and_b32 v23, s43, v30
    v_lshlrev_b32 v24, 16, v31
    v_and_b32 v25, s43, v31
    v_fma_f32 v18, v18, s44, -v6
    v_fma_f32 v19, v19, s44, -v6
    v_fma_f32 v20, v20, s44, -v6
    v_fma_f32 v21, v21, s44, -v6
    v_fma_f32 v22, v22, s44, -v6
    v_fma_f32 v23, v23, s44, -v6
    v_fma_f32 v24, v24, s44, -v6
    v_fma_f32 v25, v25, s44, -v6
    v_exp_f32 v18, v18
    v_exp_f32 v19, v19
    v_exp_f32 v20, v20
    v_exp_f32 v21, v21
    v_exp_f32 v22, v22
    v_exp_f32 v23, v23
    v_exp_f32 v24, v24
    v_exp_f32 v25, v25
    v_cvt_pk_bf16_f32 v26, v18, v19
    v_cvt_pk_bf16_f32 v27, v20, v21
    v_cvt_pk_bf16_f32 v28, v22, v23
    v_cvt_pk_bf16_f32 v29, v24, v25
    v_add_f32 v30, v18, v19
    v_add_f32 v31, v20, v21
    v_add_f32 v32, v22, v23
    v_add_f32 v33, v24, v25
    v_add_f32 v30, v30, v31
    v_add_f32 v32, v32, v33
    v_add_f32 v30, v30, v32
    v_add_f32 v5, v5, v30
    s_add_u32 s49, s46, 1
    s_cmp_ge_i32 s48, s49
    s_cbranch_scc1 L_c_v_ok
L_c_v_poll:
    s_sub_u32 s89, s89, 1
    s_cbranch_scc1 L_end
    ds_read_b128 v[34:37], v7
    s_waitcnt lgkmcnt(0)
    v_readfirstlane_b32 s48, v34
    s_nop 0
    s_cmp_ge_i32 s48, s49
    s_nop 2
    s_cbranch_scc1 L_c_v_ok
    s_sleep 1
    s_branch L_c_v_poll
L_c_v_ok:
    ds_read_b64_tr_b16 v[88:89], v10
    ds_read_b64_tr_b16 v[90:91], v10 offset:4096
    ds_read_b64_tr_b16 v[92:93], v11
    ds_read_b64_tr_b16 v[94:95], v11 offset:4096
    ds_read_b64_tr_b16 v[96:97], v12
    ds_read_b64_tr_b16 v[98:99], v12 offset:4096
    ds_read_b64_tr_b16 v[100:101], v13
    ds_read_b64_tr_b16 v[102:103], v13 offset:4096
    ds_read_b64_tr_b16 v[104:105], v14
    ds_read_b64_tr_b16 v[106:107], v14 offset:4096
    ds_read_b64_tr_b16 v[108:109], v15
    ds_read_b64_tr_b16 v[110:111], v15 offset:4096
    ds_read_b64_tr_b16 v[112:113], v16
    ds_read_b64_tr_b16 v[114:115], v16 offset:4096
    s_waitcnt lgkmcnt(6)
    v_mfma_f32_16x16x32_bf16 v[56:59], v[26:29], v[88:91], v[56:59]
    v_mfma_f32_16x16x32_bf16 v[60:63], v[26:29], v[92:95], v[60:63]
    v_mfma_f32_16x16x32_bf16 v[64:67], v[26:29], v[96:99], v[64:67]
    v_mfma_f32_16x16x32_bf16 v[68:71], v[26:29], v[100:103], v[68:71]
    ds_read_b64_tr_b16 v[116:117], v17
    ds_read_b64_tr_b16 v[118:119], v17 offset:4096
    s_waitcnt lgkmcnt(2)
    v_mfma_f32_16x16x32_bf16 v[72:75], v[26:29], v[104:107], v[72:75]
    v_mfma_f32_16x16x32_bf16 v[76:79], v[26:29], v[108:111], v[76:79]
    v_mfma_f32_16x16x32_bf16 v[80:83], v[26:29], v[112:115], v[80:83]
    s_add_u32 s46, s46, 4
    v_mov_b32 v30, s46
    s_waitcnt lgkmcnt(0)
    ds_write_b32 v38, v30
    v_mfma_f32_16x16x32_bf16 v[84:87], v[26:29], v[116:119], v[84:87]
    s_add_u32 s47, s47, 32768
    s_cmp_ge_u32 s47, 131072
    s_cselect_b32 s49, 131072, 0
    s_sub_u32 s47, s47, s49
    s_cmp_lt_u32 s46, s51
    s_nop 2
    s_cbranch_scc1 L_c_vtile
L_c_ptile:
    s_cmp_ge_u32 s46, s52
    s_cbranch_scc1 L_c_fin
L_c_ps_poll:
    s_sub_u32 s89, s89, 1
    s_cbranch_scc1 L_end
    ds_read_b128 v[34:37], v7
    s_waitcnt lgkmcnt(0)
    v_readfirstlane_b32 s52, v36
    v_readfirstlane_b32 s48, v34
    s_cmp_ge_u32 s46, s52
    s_nop 3
    s_cbranch_scc1 L_c_fin
    s_cmp_ge_i32 s48, s46
    s_cbranch_scc0 L_c_ps_poll
    s_lshr_b32 s49, s47, 7
    v_add_u32 v14, s49, v129
    ds_read_b128 v[28:31], v14
    v_add_u32 v10, s47, v3
    v_xor_b32 v11, 32, v10
    v_xor_b32 v12, 64, v10
    v_xor_b32 v13, 96, v10
    v_xor_b32 v14, 128, v10
    v_xor_b32 v15, 160, v10
    v_xor_b32 v16, 192, v10
    v_xor_b32 v17, 224, v10
    s_waitcnt lgkmcnt(0)
    v_lshlrev_b32 v18, 16, v28
    v_and_b32 v19, s43, v28
    v_lshlrev_b32 v20, 16, v29
    v_and_b32 v21, s43, v29
    v_lshlrev_b32 v22, 16, v30
    v_and_b32 v23, s43, v30
    v_lshlrev_b32 v24, 16, v31
    v_and_b32 v25, s43, v31
    v_max3_f32 v34, v18, v19, v20
    v_max3_f32 v35, v21, v22, v23
    v_max3_f32 v34, v34, v24, v25
    v_max_f32 v34, v34, v35
    v_mov_b32 v35, v34
    s_nop 1
    v_permlane32_swap_b32 v34, v35
    v_max_f32 v34, v34, v35
    v_mov_b32 v35, v34
    s_nop 1
    v_permlane16_swap_b32 v34, v35
    v_max_f32 v34, v34, v35
    v_cmp_gt_f32 vcc, v34, v4
    s_nop 4
    s_cbranch_vccz L_c_norescale
    v_sub_f32 v35, v4, v34
    v_mul_f32 v35, s44, v35
    v_exp_f32 v35, v35
    v_mov_b32 v4, v34
    v_mul_f32 v6, s44, v34
    v_mul_f32 v5, v5, v35
    v_mul_f32 v56, v56, v35
    v_mul_f32 v57, v57, v35
    v_mul_f32 v58, v58, v35
    v_mul_f32 v59, v59, v35
    v_mul_f32 v60, v60, v35
    v_mul_f32 v61, v61, v35
    v_mul_f32 v62, v62, v35
    v_mul_f32 v63, v63, v35
    v_mul_f32 v64, v64, v35
    v_mul_f32 v65, v65, v35
    v_mul_f32 v66, v66, v35
    v_mul_f32 v67, v67, v35
    v_mul_f32 v68, v68, v35
    v_mul_f32 v69, v69, v35
    v_mul_f32 v70, v70, v35
    v_mul_f32 v71, v71, v35
    v_mul_f32 v72, v72, v35
    v_mul_f32 v73, v73, v35
    v_mul_f32 v74, v74, v35
    v_mul_f32 v75, v75, v35
    v_mul_f32 v76, v76, v35
    v_mul_f32 v77, v77, v35
    v_mul_f32 v78, v78, v35
    v_mul_f32 v79, v79, v35
    v_mul_f32 v80, v80, v35
    v_mul_f32 v81, v81, v35
    v_mul_f32 v82, v82, v35
    v_mul_f32 v83, v83, v35
    v_mul_f32 v84, v84, v35
    v_mul_f32 v85, v85, v35
    v_mul_f32 v86, v86, v35
    v_mul_f32 v87, v87, v35
    s_nop 1
L_c_norescale:
    v_fma_f32 v18, v18, s44, -v6
    v_fma_f32 v19, v19, s44, -v6
    v_fma_f32 v20, v20, s44, -v6
    v_fma_f32 v21, v21, s44, -v6
    v_fma_f32 v22, v22, s44, -v6
    v_fma_f32 v23, v23, s44, -v6
    v_fma_f32 v24, v24, s44, -v6
    v_fma_f32 v25, v25, s44, -v6
    v_exp_f32 v18, v18
    v_exp_f32 v19, v19
    v_exp_f32 v20, v20
    v_exp_f32 v21, v21
    v_exp_f32 v22, v22
    v_exp_f32 v23, v23
    v_exp_f32 v24, v24
    v_exp_f32 v25, v25
    v_cvt_pk_bf16_f32 v26, v18, v19
    v_cvt_pk_bf16_f32 v27, v20, v21
    v_cvt_pk_bf16_f32 v28, v22, v23
    v_cvt_pk_bf16_f32 v29, v24, v25
    v_add_f32 v30, v18, v19
    v_add_f32 v31, v20, v21
    v_add_f32 v32, v22, v23
    v_add_f32 v33, v24, v25
    v_add_f32 v30, v30, v31
    v_add_f32 v32, v32, v33
    v_add_f32 v30, v30, v32
    v_add_f32 v5, v5, v30
    s_add_u32 s49, s46, 1
    s_cmp_ge_i32 s48, s49
    s_cbranch_scc1 L_c_pv_ok
L_c_pv_poll:
    s_sub_u32 s89, s89, 1
    s_cbranch_scc1 L_end
    ds_read_b128 v[34:37], v7
    s_waitcnt lgkmcnt(0)
    v_readfirstlane_b32 s48, v34
    s_nop 0
    s_cmp_ge_i32 s48, s49
    s_nop 2
    s_cbranch_scc1 L_c_pv_ok
    s_branch L_c_pv_poll
L_c_pv_ok:
    ds_read_b64_tr_b16 v[88:89], v10
    ds_read_b64_tr_b16 v[90:91], v10 offset:4096
    ds_read_b64_tr_b16 v[92:93], v11
    ds_read_b64_tr_b16 v[94:95], v11 offset:4096
    ds_read_b64_tr_b16 v[96:97], v12
    ds_read_b64_tr_b16 v[98:99], v12 offset:4096
    ds_read_b64_tr_b16 v[100:101], v13
    ds_read_b64_tr_b16 v[102:103], v13 offset:4096
    ds_read_b64_tr_b16 v[104:105], v14
    ds_read_b64_tr_b16 v[106:107], v14 offset:4096
    ds_read_b64_tr_b16 v[108:109], v15
    ds_read_b64_tr_b16 v[110:111], v15 offset:4096
    ds_read_b64_tr_b16 v[112:113], v16
    ds_read_b64_tr_b16 v[114:115], v16 offset:4096
    s_waitcnt lgkmcnt(6)
    v_mfma_f32_16x16x32_bf16 v[56:59], v[26:29], v[88:91], v[56:59]
    v_mfma_f32_16x16x32_bf16 v[60:63], v[26:29], v[92:95], v[60:63]
    v_mfma_f32_16x16x32_bf16 v[64:67], v[26:29], v[96:99], v[64:67]
    v_mfma_f32_16x16x32_bf16 v[68:71], v[26:29], v[100:103], v[68:71]
    ds_read_b64_tr_b16 v[116:117], v17
    ds_read_b64_tr_b16 v[118:119], v17 offset:4096
    s_waitcnt lgkmcnt(2)
    v_mfma_f32_16x16x32_bf16 v[72:75], v[26:29], v[104:107], v[72:75]
    v_mfma_f32_16x16x32_bf16 v[76:79], v[26:29], v[108:111], v[76:79]
    v_mfma_f32_16x16x32_bf16 v[80:83], v[26:29], v[112:115], v[80:83]
    s_add_u32 s46, s46, 4
    v_mov_b32 v30, s46
    s_waitcnt lgkmcnt(0)
    ds_write_b32 v38, v30
    v_mfma_f32_16x16x32_bf16 v[84:87], v[26:29], v[116:119], v[84:87]
    s_add_u32 s47, s47, 32768
    s_cmp_ge_u32 s47, 131072
    s_cselect_b32 s49, 131072, 0
    s_sub_u32 s47, s47, s49
    s_nop 3
    s_branch L_c_ptile
L_c_fin:
    v_mov_b32 v30, v5
    v_mov_b32 v4, v6
    ds_write_b32 v120, v56 offset:0
    v_permlane32_swap_b32 v5, v30
    ds_write_b32 v120, v60 offset:64
    ds_write_b32 v120, v64 offset:128
    v_add_f32 v5, v5, v30
    ds_write_b32 v120, v68 offset:192
    v_mov_b32 v30, v5
    ds_write_b32 v120, v72 offset:256
    ds_write_b32 v120, v76 offset:320
    v_permlane16_swap_b32 v5, v30
    ds_write_b32 v120, v80 offset:384
    ds_write_b32 v120, v84 offset:448
    v_add_f32 v5, v5, v30
    ds_write_b64 v121, v[4:5]
    s_mov_b64 exec, 1
    ds_add_rtn_u32 v32, v122, v123
    s_mov_b64 exec, -1
    ds_read_b128 v[20:23], v126
    ds_read_b128 v[24:27], v126 offset:16
    ds_read_b64 v[12:13], v124
    ds_read_b64 v[14:15], v124 offset:512
    ds_read_b64 v[16:17], v124 offset:1024
    ds_read_b64 v[18:19], v124 offset:1536
    s_waitcnt lgkmcnt(0)
    v_readfirstlane_b32 s41, v32
    v_max3_f32 v28, v20, v22, v24
    s_cmp_eq_u32 s41, 3
    s_nop 2
    s_cbranch_scc0 L_end
    ds_write_b32 v127, v123
    v_max_f32 v28, v28, v26
    v_sub_f32 v20, v20, v28
    v_sub_f32 v22, v22, v28
    v_sub_f32 v24, v24, v28
    v_sub_f32 v26, v26, v28
    v_exp_f32 v20, v20
    v_exp_f32 v22, v22
    v_exp_f32 v24, v24
    v_exp_f32 v26, v26
    v_pk_mul_f32 v[12:13], v[12:13], v[20:21] op_sel_hi:[1,0]
    v_mul_f32 v29, v21, v20
    v_pk_fma_f32 v[12:13], v[14:15], v[22:23], v[12:13] op_sel_hi:[1,0,1]
    v_fmac_f32 v29, v23, v22
    v_pk_fma_f32 v[12:13], v[16:17], v[24:25], v[12:13] op_sel_hi:[1,0,1]
    v_fmac_f32 v29, v25, v24
    v_pk_fma_f32 v[12:13], v[18:19], v[26:27], v[12:13] op_sel_hi:[1,0,1]
    v_fmac_f32 v29, v27, v26
    global_store_dwordx2 v125, v[12:13], s[26:27] sc1
    s_mov_b64 exec, 0xffff
    global_store_dwordx2 v125, v[28:29], s[26:27] offset:512 sc1
    s_mov_b64 exec, -1
    s_endpgm
L_tail:
    s_sub_u32 s40, s28, 5
    s_mov_b32 s43, 0xffff0000
    s_mov_b32 s54, 0
    s_mov_b32 s44, 0
    s_cmp_eq_u32 s31, 4
    s_cbranch_scc0 L_t_r0
    s_cmp_lt_u32 s29, 16
    s_cbranch_scc0 L_t_rdone
    s_mov_b32 s54, 3
    s_mov_b32 s44, s29
    s_branch L_t_rdone
L_t_r0:
    s_cmp_lt_u32 s29, 11
    s_cbranch_scc0 L_t_r1
    s_cmp_lt_u32 s31, 3
    s_cbranch_scc0 L_t_rdone
    s_mov_b32 s54, 1
    s_mov_b32 s44, s29
    s_cmp_eq_u32 s31, 0
    s_cbranch_scc1 L_t_rdone
    s_mov_b32 s54, 2
    s_lshl_b32 s44, s29, 1
    s_add_u32 s44, s44, s31
    s_sub_u32 s44, s44, 1
    s_branch L_t_rdone
L_t_r1:
    s_cmp_lt_u32 s29, 22
    s_cbranch_scc0 L_t_r2
    s_cmp_lt_u32 s31, 4
    s_cbranch_scc0 L_t_rdone
    s_mov_b32 s54, 2
    s_add_u32 s44, s29, 11
    s_cmp_eq_u32 s31, 3
    s_cbranch_scc1 L_t_rdone
    s_mov_b32 s54, 1
    s_mul_i32 s44, s29, 3
    s_add_u32 s44, s44, s31
    s_sub_u32 s44, s44, 22
    s_branch L_t_rdone
L_t_r2:
    s_cmp_lt_u32 s31, 3
    s_cbranch_scc0 L_t_rdone
    s_mov_b32 s54, 2
    s_add_u32 s44, s29, 11
    s_cmp_eq_u32 s31, 2
    s_cbranch_scc1 L_t_rdone
    s_mov_b32 s54, 1
    s_lshl_b32 s44, s29, 1
    s_add_u32 s44, s44, s31
L_t_rdone:
    s_barrier
    v_lshrrev_b32 v8, 4, v1
    v_and_b32 v9, 15, v1
    s_cmp_eq_u32 s40, 0
    s_nop 0
    s_cbranch_scc0 L_t_noclear
    v_mov_b32 v10, -1
    v_mov_b32 v11, -1
    v_mov_b32 v12, -1
    v_mov_b32 v13, -1
    s_mul_i32 s41, s3, 640
    v_lshlrev_b32 v4, 3, v1
    v_add_u32 v4, s41, v4
    global_store_dwordx2 v4, v[10:11], s[26:27] sc1
    s_mov_b64 exec, 0xffff
    global_store_dwordx2 v4, v[10:11], s[26:27] offset:512 sc1
    s_mov_b64 exec, -1
    s_cmp_eq_u32 s30, 0
    s_cbranch_scc0 L_t_clr_tk
    s_lshl_b32 s41, s29, 8
    s_add_u32 s41, s41, 557056
    v_mov_b32 v4, s41
    v_mov_b32 v5, 0
    global_store_dword v4, v5, s[26:27] sc1
    global_store_dword v4, v5, s[26:27] offset:128 sc1
L_t_clr_tk:
    s_cmp_eq_u32 s54, 1
    s_cbranch_scc0 L_t_clr_f
    s_lshl_b32 s41, s44, 8
    s_add_u32 s41, s41, 167936
    v_lshlrev_b32 v4, 2, v1
    v_add_u32 v4, s41, v4
    global_store_dword v4, v10, s[26:27] sc1
    s_nop 0
    s_branch L_t_clr_done
L_t_clr_f:
    s_cmp_eq_u32 s54, 2
    s_cbranch_scc0 L_t_clr_done
    s_lshl_b32 s41, s44, 11
    s_add_u32 s41, s41, 196608
    v_lshlrev_b32 v4, 4, v1
    v_add_u32 v4, s41, v4
    global_store_dwordx4 v4, v[10:13], s[26:27] sc1
    global_store_dwordx4 v4, v[10:13], s[26:27] offset:1024 sc1
    s_nop 1
L_t_clr_done:
    s_waitcnt vmcnt(0)
    v_mov_b32 v4, 147492
    v_mov_b32 v5, 1
    ds_write_b32 v4, v5
    s_nop 0
L_t_noclear:
    s_cmp_eq_u32 s54, 0
    s_cbranch_scc0 L_t_hasrole
    s_cmp_eq_u32 s40, 0
    s_cbranch_scc0 L_end
    v_mov_b32 v4, 147468
    s_nop 1
L_n_k_pc:
    s_sub_u32 s89, s89, 1
    s_cbranch_scc1 L_end
    ds_read_b32 v5, v4
    s_waitcnt lgkmcnt(0)
    v_readfirstlane_b32 s42, v5
    s_nop 0
    s_cmp_ge_u32 s42, 256
    s_nop 2
    s_cbranch_scc1 L_n_k_pcok
    s_sleep 16
    s_branch L_n_k_pc
L_n_k_pcok:
    v_mov_b32 v4, 147504
    ds_read_b64 v[16:17], v4
    s_lshl_b32 s42, s3, 3
    s_add_u32 s42, s42, 589824
    v_mov_b32 v4, s42
    s_waitcnt lgkmcnt(0)
    s_mov_b64 exec, 1
    global_store_dwordx2 v4, v[16:17], s[26:27] sc1
    s_mov_b64 exec, -1
    s_lshl_b32 s42, s29, 6
    s_add_u32 s42, s42, 589824
    v_and_b32 v4, 7, v1
    v_lshlrev_b32 v4, 3, v4
    v_add_u32 v4, s42, v4
    s_nop 1
L_n_k_kd:
    s_sub_u32 s89, s89, 1
    s_cbranch_scc1 L_end
    global_load_dwordx2 v[20:21], v4, s[26:27] sc1
    s_waitcnt vmcnt(0)
    v_xor_b32 v5, v16, v20
    v_xor_b32 v18, v17, v21
    v_or_b32 v5, v5, v18
    v_cmp_ne_u32 vcc, 0, v5
    s_nop 4
    s_cbranch_vccz L_n_k_kdok
    s_sleep 16
    s_branch L_n_k_kd
L_n_k_kdok:
    v_mov_b32 v4, 147512
    v_mov_b32 v5, 1
    ds_write_b32 v4, v5
    s_endpgm
L_t_hasrole:
    s_cmp_eq_u32 s54, 3
    s_cbranch_scc0 L_t_wf
    s_cmp_eq_u32 s40, 0
    s_cbranch_scc1 L_t_o
    s_endpgm
L_t_wf:
    v_mov_b32 v4, 147500
    s_nop 1
L_t_qw:
    s_sub_u32 s89, s89, 1
    s_cbranch_scc1 L_end
    ds_read_b32 v5, v4
    s_waitcnt lgkmcnt(0)
    v_readfirstlane_b32 s42, v5
    s_nop 0
    s_cmp_lg_u32 s42, 0
    s_nop 2
    s_cbranch_scc1 L_t_qw_ok
    s_sleep 8
    s_branch L_t_qw
L_t_qw_ok:
    s_cmp_eq_u32 s54, 2
    s_cbranch_scc1 L_t_f
L_t_w:
    s_lshl_b32 s41, s40, 12
    s_add_u32 s41, s41, 131072
    v_lshrrev_b32 v10, 2, v9
    v_lshlrev_b32 v11, 3, v8
    v_add_u32 v10, v10, v11
    v_mul_u32_u24 v10, 128, v10
    v_and_b32 v11, 3, v9
    v_lshlrev_b32 v11, 3, v11
    v_add_u32 v10, v10, v11
    v_add_u32 v14, s41, v10
    s_lshr_b32 s45, s44, 3
    s_and_b32 s46, s44, 7
    s_lshl_b32 s47, s45, 19
    s_lshl_b32 s48, s40, 17
    s_add_u32 s47, s47, s48
    s_lshl_b32 s48, s46, 7
    s_add_u32 s47, s47, s48
    v_lshrrev_b32 v10, 3, v1
    v_lshlrev_b32 v10, 10, v10
    v_and_b32 v11, 7, v1
    v_lshlrev_b32 v11, 4, v11
    v_add_u32 v10, v10, v11
    v_add_u32 v10, s47, v10
    v_mov_b32 v13, s13
    v_add_co_u32 v12, vcc, s12, v10
    s_nop 1
    v_addc_co_u32 v13, vcc, 0, v13, vcc
    s_add_u32 m0, s41, 0
    s_nop 0
    global_load_lds_dwordx4 v[12:13], off nt
    v_add_co_u32 v12, vcc, 8192, v12
    s_nop 1
    v_addc_co_u32 v13, vcc, 0, v13, vcc
    s_add_u32 m0, s41, 1024
    s_nop 0
    global_load_lds_dwordx4 v[12:13], off nt
    v_add_co_u32 v12, vcc, 8192, v12
    s_nop 1
    v_addc_co_u32 v13, vcc, 0, v13, vcc
    s_add_u32 m0, s41, 2048
    s_nop 0
    global_load_lds_dwordx4 v[12:13], off nt
    v_add_co_u32 v12, vcc, 8192, v12
    s_nop 1
    v_addc_co_u32 v13, vcc, 0, v13, vcc
    s_add_u32 m0, s41, 3072
    s_nop 0
    global_load_lds_dwordx4 v[12:13], off nt
    v_add_co_u32 v12, vcc, 8192, v12
    s_nop 1
    v_addc_co_u32 v13, vcc, 0, v13, vcc
    s_waitcnt vmcnt(0)
    ds_read_b64_tr_b16 v[64:65], v14 offset:0
    ds_read_b64_tr_b16 v[66:67], v14 offset:512
    ds_read_b64_tr_b16 v[68:69], v14 offset:32
    ds_read_b64_tr_b16 v[70:71], v14 offset:544
    ds_read_b64_tr_b16 v[72:73], v14 offset:64
    ds_read_b64_tr_b16 v[74:75], v14 offset:576
    ds_read_b64_tr_b16 v[76:77], v14 offset:96
    ds_read_b64_tr_b16 v[78:79], v14 offset:608
    s_waitcnt lgkmcnt(0)
    s_mov_b32 s64, s12
    s_and_b32 s65, s13, 0xffff
    s_mov_b32 s66, 0x400000
    s_mov_b32 s67, 0x20000
    v_lshrrev_b32 v45, 3, v1
    v_lshlrev_b32 v45, 10, v45
    v_and_b32 v11, 7, v1
    v_lshlrev_b32 v11, 4, v11
    v_add_u32 v45, v45, v11
    s_lshl_b32 s55, s40, 14
    s_lshl_b32 s56, s45, 19
    s_lshl_b32 s57, s40, 17
    s_add_u32 s56, s56, s57
    s_lshl_b32 s57, s46, 7
    s_add_u32 s56, s56, s57
    s_mov_b32 s41, s55
    v_lshrrev_b32 v10, 2, v9
    v_lshlrev_b32 v11, 3, v8
    v_add_u32 v10, v10, v11
    v_mul_u32_u24 v10, 128, v10
    v_and_b32 v11, 3, v9
    v_lshlrev_b32 v11, 3, v11
    v_add_u32 v10, v10, v11
    v_add_u32 v47, s41, v10
    s_lshl_b32 s47, s45, 2
    s_add_u32 s47, s47, s40
    s_mul_i32 s48, s47, 5120
    s_lshl_b32 s59, s40, 12
    s_add_u32 s59, s59, 131072
    s_mov_b32 s41, s59
    v_lshrrev_b32 v10, 2, v9
    v_lshlrev_b32 v11, 3, v8
    v_add_u32 v10, v10, v11
    v_mul_u32_u24 v10, 128, v10
    v_and_b32 v11, 3, v9
    v_lshlrev_b32 v11, 3, v11
    v_add_u32 v10, v10, v11
    v_add_u32 v46, s41, v10
    v_lshlrev_b32 v44, 4, v1
    v_add_u32 v44, s55, v44
    s_cmp_eq_u32 s40, 0
    s_nop 0
    s_cbranch_scc0 L_w_nok
    v_mov_b32 v4, 147468
    s_nop 1
L_w_k_pc:
    s_sub_u32 s89, s89, 1
    s_cbranch_scc1 L_end
    ds_read_b32 v5, v4
    s_waitcnt lgkmcnt(0)
    v_readfirstlane_b32 s42, v5
    s_nop 0
    s_cmp_ge_u32 s42, 256
    s_nop 2
    s_cbranch_scc1 L_w_k_pcok
    s_sleep 16
    s_branch L_w_k_pc
L_w_k_pcok:
    v_mov_b32 v4, 147504
    ds_read_b64 v[16:17], v4
    s_lshl_b32 s42, s3, 3
    s_add_u32 s42, s42, 589824
    v_mov_b32 v4, s42
    s_waitcnt lgkmcnt(0)
    s_mov_b64 exec, 1
    global_store_dwordx2 v4, v[16:17], s[26:27] sc1
    s_mov_b64 exec, -1
    s_lshl_b32 s42, s29, 6
    s_add_u32 s42, s42, 589824
    v_and_b32 v4, 7, v1
    v_lshlrev_b32 v4, 3, v4
    v_add_u32 v4, s42, v4
    s_nop 1
L_w_k_kd:
    s_sub_u32 s89, s89, 1
    s_cbranch_scc1 L_end
    global_load_dwordx2 v[20:21], v4, s[26:27] sc1
    s_waitcnt vmcnt(0)
    v_xor_b32 v5, v16, v20
    v_xor_b32 v18, v17, v21
    v_or_b32 v5, v5, v18
    v_cmp_ne_u32 vcc, 0, v5
    s_nop 4
    s_cbranch_vccz L_w_k_kdok
    s_sleep 16
    s_branch L_w_k_kd
L_w_k_kdok:
    v_mov_b32 v4, 147512
    v_mov_b32 v5, 1
    ds_write_b32 v4, v5
    s_nop 0
L_w_nok:
    v_mov_b32 v4, 147504
    ds_read_b64 v[16:17], v4
    v_lshlrev_b32 v4, 4, v1
    v_add_u32 v4, 573440, v4
    s_waitcnt lgkmcnt(0)
    s_nop 0
L_w_clr:
    s_sub_u32 s89, s89, 1
    s_cbranch_scc1 L_end
    global_load_dwordx4 v[20:23], v4, s[26:27] sc1
    global_load_dwordx4 v[24:27], v4, s[26:27] offset:1024 sc1
    s_waitcnt vmcnt(0)
    v_xor_b32 v5, v16, v20
    v_xor_b32 v18, v16, v22
    v_or_b32 v5, v5, v18
    v_xor_b32 v18, v16, v24
    v_or_b32 v5, v5, v18
    v_xor_b32 v18, v16, v26
    v_or_b32 v5, v5, v18
    v_xor_b32 v18, v17, v21
    v_or_b32 v5, v5, v18
    v_xor_b32 v18, v17, v23
    v_or_b32 v5, v5, v18
    v_xor_b32 v18, v17, v25
    v_or_b32 v5, v5, v18
    v_xor_b32 v18, v17, v27
    v_or_b32 v5, v5, v18
    v_cmp_ne_u32 vcc, 0, v5
    s_nop 4
    s_cbranch_vccz L_w_go0
    s_sleep 32
    s_branch L_w_clr
L_w_go0:
    v_mov_b32 v4, 147464
    s_nop 1
L_w_fv:
    s_sub_u32 s89, s89, 1
    s_cbranch_scc1 L_end
    ds_read_b32 v5, v4
    s_waitcnt lgkmcnt(0)
    v_readfirstlane_b32 s42, v5
    s_nop 0
    s_cmp_lg_u32 s42, 0x7fffffff
    s_nop 2
    s_cbranch_scc1 L_w_fv_ok
    s_sleep 2
    s_branch L_w_fv
L_w_fv_ok:
    s_add_u32 m0, s59, 0
    s_add_u32 s58, s56, 32768
    buffer_load_dwordx4 v45, s[64:67], s58 offen nt lds
    s_add_u32 m0, s59, 1024
    s_add_u32 s58, s56, 40960
    buffer_load_dwordx4 v45, s[64:67], s58 offen nt lds
    s_add_u32 m0, s59, 2048
    s_add_u32 s58, s56, 49152
    buffer_load_dwordx4 v45, s[64:67], s58 offen nt lds
    s_add_u32 m0, s59, 3072
    s_add_u32 s58, s56, 57344
    buffer_load_dwordx4 v45, s[64:67], s58 offen nt lds
    s_add_u32 s58, s56, 65536
    buffer_load_dwordx4 v[128:131], v45, s[64:67], s58 offen nt
    s_add_u32 s58, s56, 73728
    buffer_load_dwordx4 v[132:135], v45, s[64:67], s58 offen nt
    s_add_u32 s58, s56, 81920
    buffer_load_dwordx4 v[136:139], v45, s[64:67], s58 offen nt
    s_add_u32 s58, s56, 90112
    buffer_load_dwordx4 v[140:143], v45, s[64:67], s58 offen nt
    s_add_u32 s58, s56, 98304
    buffer_load_dwordx4 v[144:147], v45, s[64:67], s58 offen nt
    s_add_u32 s58, s56, 106496
    buffer_load_dwordx4 v[148:151], v45, s[64:67], s58 offen nt
    s_add_u32 s58, s56, 114688
    buffer_load_dwordx4 v[152:155], v45, s[64:67], s58 offen nt
    s_add_u32 s58, s56, 122880
    buffer_load_dwordx4 v[156:159], v45, s[64:67], s58 offen nt
    v_mov_b32 v4, 147496
    s_nop 1
L_w_go:
    s_sub_u32 s89, s89, 1
    s_cbranch_scc1 L_end
    ds_read_b32 v5, v4
    s_waitcnt lgkmcnt(0)
    v_readfirstlane_b32 s42, v5
    s_nop 0
    s_cmp_lg_u32 s42, 0
    s_nop 2
    s_cbranch_scc1 L_w_go_ok
    s_sleep 1
    s_branch L_w_go
L_w_go_ok:
    s_waitcnt vmcnt(0)
    ds_write_b128 v44, v[128:131] offset:8192
    ds_write_b128 v44, v[132:135] offset:9216
    ds_write_b128 v44, v[136:139] offset:10240
    ds_write_b128 v44, v[140:143] offset:11264
    ds_write_b128 v44, v[144:147] offset:12288
    ds_write_b128 v44, v[148:151] offset:13312
    ds_write_b128 v44, v[152:155] offset:14336
    ds_write_b128 v44, v[156:159] offset:15360
    s_waitcnt lgkmcnt(0)
    v_lshrrev_b32 v15, 5, v1
    v_mul_u32_u24 v15, 640, v15
    v_add_u32 v15, s48, v15
    v_and_b32 v10, 31, v1
    v_lshlrev_b32 v14, 4, v10
    v_add_u32 v14, v15, v14
    v_add_u32 v15, 512, v15
    v_lshlrev_b32 v10, 3, v10
    s_lshl_b32 s47, s40, 8
    s_add_u32 s47, s47, 150080
    v_add_u32 v7, s47, v10
    v_lshlrev_b32 v10, 4, v8
    v_add_u32 v10, s47, v10
    s_lshl_b32 s47, s44, 8
    s_add_u32 s47, s47, 167936
    v_lshlrev_b32 v6, 2, v1
    v_add_u32 v6, s47, v6
    s_lshl_b32 s47, s40, 8
    s_add_u32 s47, s47, 152384
    v_lshlrev_b32 v11, 2, v9
    v_add_u32 v11, s47, v11
    v_lshlrev_b32 v5, 2, v1
    v_add_u32 v5, 152384, v5
    s_waitcnt vmcnt(0)
    ds_read_b64_tr_b16 v[80:81], v46 offset:0
    ds_read_b64_tr_b16 v[82:83], v46 offset:512
    ds_read_b64_tr_b16 v[84:85], v46 offset:32
    ds_read_b64_tr_b16 v[86:87], v46 offset:544
    ds_read_b64_tr_b16 v[88:89], v46 offset:64
    ds_read_b64_tr_b16 v[90:91], v46 offset:576
    ds_read_b64_tr_b16 v[92:93], v46 offset:96
    ds_read_b64_tr_b16 v[94:95], v46 offset:608
    s_waitcnt lgkmcnt(0)
    ds_read_b64_tr_b16 v[96:97], v47 offset:8192
    ds_read_b64_tr_b16 v[98:99], v47 offset:8704
    ds_read_b64_tr_b16 v[100:101], v47 offset:8224
    ds_read_b64_tr_b16 v[102:103], v47 offset:8736
    ds_read_b64_tr_b16 v[104:105], v47 offset:8256
    ds_read_b64_tr_b16 v[106:107], v47 offset:8768
    ds_read_b64_tr_b16 v[108:109], v47 offset:8288
    ds_read_b64_tr_b16 v[110:111], v47 offset:8800
    s_waitcnt lgkmcnt(0)
    ds_read_b64_tr_b16 v[112:113], v47 offset:12288
    ds_read_b64_tr_b16 v[114:115], v47 offset:12800
    ds_read_b64_tr_b16 v[116:117], v47 offset:12320
    ds_read_b64_tr_b16 v[118:119], v47 offset:12832
    ds_read_b64_tr_b16 v[120:121], v47 offset:12352
    ds_read_b64_tr_b16 v[122:123], v47 offset:12864
    ds_read_b64_tr_b16 v[124:125], v47 offset:12384
    ds_read_b64_tr_b16 v[126:127], v47 offset:12896
    s_waitcnt lgkmcnt(0)
L_w_poll:
    s_sub_u32 s89, s89, 1
    s_cbranch_scc1 L_end
    global_load_dwordx4 v[16:19], v14, s[26:27] offset:0 sc1
    global_load_dwordx4 v[20:23], v14, s[26:27] offset:1280 sc1
    global_load_dwordx4 v[24:27], v14, s[26:27] offset:2560 sc1
    global_load_dwordx4 v[28:31], v14, s[26:27] offset:3840 sc1
    global_load_dwordx2 v[32:33], v15, s[26:27] offset:0 sc1
    global_load_dwordx2 v[34:35], v15, s[26:27] offset:1280 sc1
    global_load_dwordx2 v[36:37], v15, s[26:27] offset:2560 sc1
    global_load_dwordx2 v[38:39], v15, s[26:27] offset:3840 sc1
    s_waitcnt vmcnt(0)
    v_max3_u32 v13, v16, v17, v18
    v_max3_u32 v13, v13, v19, v20
    v_max3_u32 v13, v13, v21, v22
    v_max3_u32 v13, v13, v23, v24
    v_max3_u32 v13, v13, v25, v26
    v_max3_u32 v13, v13, v27, v28
    v_max3_u32 v13, v13, v29, v30
    v_max3_u32 v13, v13, v31, v32
    v_max3_u32 v13, v13, v33, v34
    v_max3_u32 v13, v13, v35, v36
    v_max3_u32 v13, v13, v37, v38
    v_max_u32 v13, v13, v39
    v_cmp_eq_u32 vcc, -1, v13
    s_nop 4
    s_cbranch_vccnz L_w_poll
    v_max3_f32 v2, v32, v34, v36
    v_max_f32 v2, v2, v38
    v_mov_b32 v3, v2
    s_nop 1
    v_permlane32_swap_b32 v2, v3
    v_max_f32 v2, v2, v3
    v_sub_f32 v32, v32, v2
    v_sub_f32 v34, v34, v2
    v_sub_f32 v36, v36, v2
    v_sub_f32 v38, v38, v2
    v_exp_f32 v32, v32
    v_exp_f32 v34, v34
    v_exp_f32 v36, v36
    v_exp_f32 v38, v38
    v_pk_mul_f32 v[12:13], v[16:17], v[32:33] op_sel_hi:[1,0]
    v_pk_mul_f32 v[2:3], v[18:19], v[32:33] op_sel_hi:[1,0]
    v_mul_f32 v4, v32, v33
    v_pk_fma_f32 v[12:13], v[20:21], v[34:35], v[12:13] op_sel_hi:[1,0,1]
    v_pk_fma_f32 v[2:3], v[22:23], v[34:35], v[2:3] op_sel_hi:[1,0,1]
    v_fmac_f32 v4, v34, v35
    v_pk_fma_f32 v[12:13], v[24:25], v[36:37], v[12:13] op_sel_hi:[1,0,1]
    v_pk_fma_f32 v[2:3], v[26:27], v[36:37], v[2:3] op_sel_hi:[1,0,1]
    v_fmac_f32 v4, v36, v37
    v_pk_fma_f32 v[12:13], v[28:29], v[38:39], v[12:13] op_sel_hi:[1,0,1]
    v_pk_fma_f32 v[2:3], v[30:31], v[38:39], v[2:3] op_sel_hi:[1,0,1]
    v_fmac_f32 v4, v38, v39
    v_mov_b32 v128, v12
    v_mov_b32 v129, v13
    v_mov_b32 v130, v2
    v_mov_b32 v131, v3
    v_mov_b32 v132, v4
    v_permlane32_swap_b32 v12, v128
    v_permlane32_swap_b32 v13, v129
    v_permlane32_swap_b32 v2, v130
    v_permlane32_swap_b32 v3, v131
    v_permlane32_swap_b32 v4, v132
    v_add_f32 v4, v4, v132
    v_pk_add_f32 v[12:13], v[12:13], v[128:129]
    v_rcp_f32 v132, v4
    v_pk_add_f32 v[2:3], v[2:3], v[130:131]
    v_pk_mul_f32 v[12:13], v[12:13], v[132:133] op_sel_hi:[1,0]
    v_pk_mul_f32 v[2:3], v[2:3], v[132:133] op_sel_hi:[1,0]
    v_cvt_pk_bf16_f32 v12, v12, v13
    v_cvt_pk_bf16_f32 v13, v2, v3
    ds_write_b64 v7, v[12:13]
    s_waitcnt lgkmcnt(0)
    ds_read_b128 v[128:131], v10 offset:0
    ds_read_b128 v[132:135], v10 offset:64
    ds_read_b128 v[136:139], v10 offset:128
    ds_read_b128 v[140:143], v10 offset:192
    s_waitcnt lgkmcnt(3)
    v_mfma_f32_16x16x32_bf16 v[144:147], v[128:131], v[64:67], 0
    v_mfma_f32_16x16x32_bf16 v[148:151], v[128:131], v[68:71], 0
    v_mfma_f32_16x16x32_bf16 v[152:155], v[128:131], v[72:75], 0
    v_mfma_f32_16x16x32_bf16 v[156:159], v[128:131], v[76:79], 0
    s_waitcnt lgkmcnt(2)
    v_mfma_f32_16x16x32_bf16 v[144:147], v[132:135], v[80:83], v[144:147]
    v_mfma_f32_16x16x32_bf16 v[148:151], v[132:135], v[84:87], v[148:151]
    v_mfma_f32_16x16x32_bf16 v[152:155], v[132:135], v[88:91], v[152:155]
    v_mfma_f32_16x16x32_bf16 v[156:159], v[132:135], v[92:95], v[156:159]
    s_waitcnt lgkmcnt(1)
    v_mfma_f32_16x16x32_bf16 v[144:147], v[136:139], v[96:99], v[144:147]
    v_mfma_f32_16x16x32_bf16 v[148:151], v[136:139], v[100:103], v[148:151]
    v_mfma_f32_16x16x32_bf16 v[152:155], v[136:139], v[104:107], v[152:155]
    v_mfma_f32_16x16x32_bf16 v[156:159], v[136:139], v[108:111], v[156:159]
    s_waitcnt lgkmcnt(0)
    v_mfma_f32_16x16x32_bf16 v[144:147], v[140:143], v[112:115], v[144:147]
    v_mfma_f32_16x16x32_bf16 v[148:151], v[140:143], v[116:119], v[148:151]
    v_mfma_f32_16x16x32_bf16 v[152:155], v[140:143], v[120:123], v[152:155]
    v_mfma_f32_16x16x32_bf16 v[156:159], v[140:143], v[124:127], v[156:159]
    s_nop 4
    ds_write_b32 v11, v144 offset:0
    ds_write_b32 v11, v148 offset:64
    ds_write_b32 v11, v152 offset:128
    ds_write_b32 v11, v156 offset:192
    s_waitcnt lgkmcnt(0)
    s_barrier
    ds_read_b32 v12, v5
    ds_read_b32 v13, v5 offset:256
    ds_read_b32 v14, v5 offset:512
    ds_read_b32 v15, v5 offset:768
    s_waitcnt lgkmcnt(0)
    v_add_f32 v12, v12, v13
    v_add_f32 v14, v14, v15
    v_add_f32 v12, v12, v14
    s_cmp_eq_u32 s40, 0
    s_nop 0
    s_cbranch_scc0 L_end
    global_store_dword v6, v12, s[26:27] sc1
    s_endpgm
L_t_f:
    v_mov_b32 v4, 0
    global_load_dword v5, v4, s[16:17] nt
    global_load_dword v10, v4, s[18:19] nt
    global_load_dword v11, v4, s[20:21] nt
    s_waitcnt vmcnt(0)
    s_lshl_b32 s41, s40, 12
    s_add_u32 s41, s41, 131072
    v_lshrrev_b32 v10, 2, v9
    v_lshlrev_b32 v11, 3, v8
    v_add_u32 v10, v10, v11
    v_mul_u32_u24 v10, 64, v10
    v_and_b32 v11, 3, v9
    v_lshlrev_b32 v11, 3, v11
    v_add_u32 v10, v10, v11
    v_add_u32 v14, s41, v10
    s_lshl_b32 s46, s44, 6
    s_mul_i32 s47, s40, 352256
    s_add_u32 s46, s46, s47
    v_lshrrev_b32 v10, 2, v1
    v_mul_u32_u24 v10, 2752, v10
    v_and_b32 v11, 3, v1
    v_lshlrev_b32 v11, 4, v11
    v_add_u32 v10, v10, v11
    v_add_u32 v10, s46, v10
    v_mov_b32 v13, s17
    v_add_co_u32 v12, vcc, s16, v10
    s_nop 1
    v_addc_co_u32 v13, vcc, 0, v13, vcc
    v_mov_b32 v17, s19
    v_add_co_u32 v16, vcc, s18, v10
    s_nop 1
    v_addc_co_u32 v17, vcc, 0, v17, vcc
    s_mov_b32 s64, s16
    s_and_b32 s65, s17, 0xffff
    s_mov_b32 s66, 1409024
    s_mov_b32 s67, 0x20000
    s_mov_b32 s68, s18
    s_and_b32 s69, s19, 0xffff
    s_mov_b32 s70, 1409024
    s_mov_b32 s71, 0x20000
    s_mov_b32 s72, s20
    s_and_b32 s73, s21, 0xffff
    s_mov_b32 s74, 1409024
    s_mov_b32 s75, 0x20000
    v_lshrrev_b32 v44, 2, v1
    v_mul_u32_u24 v44, 2752, v44
    v_and_b32 v11, 3, v1
    v_lshlrev_b32 v11, 4, v11
    v_add_u32 v44, v44, v11
    v_lshrrev_b32 v45, 3, v1
    v_lshlrev_b32 v45, 10, v45
    v_and_b32 v11, 7, v1
    v_lshlrev_b32 v11, 4, v11
    v_add_u32 v45, v45, v11
    s_mul_i32 s55, s40, 24576
    s_mul_i32 s56, s40, 352256
    s_lshl_b32 s57, s44, 6
    s_add_u32 s56, s56, s57
    s_lshl_b32 s57, s44, 15
    s_lshl_b32 s58, s40, 8
    s_add_u32 s57, s57, s58
    s_mov_b32 s41, s55
    v_lshrrev_b32 v10, 2, v9
    v_lshlrev_b32 v11, 3, v8
    v_add_u32 v10, v10, v11
    v_mul_u32_u24 v10, 64, v10
    v_and_b32 v11, 3, v9
    v_lshlrev_b32 v11, 3, v11
    v_add_u32 v10, v10, v11
    v_add_u32 v46, s41, v10
    s_add_u32 s41, s55, 16384
    v_lshrrev_b32 v10, 2, v9
    v_lshlrev_b32 v11, 3, v8
    v_add_u32 v10, v10, v11
    v_mul_u32_u24 v10, 128, v10
    v_and_b32 v11, 3, v9
    v_lshlrev_b32 v11, 3, v11
    v_add_u32 v10, v10, v11
    v_add_u32 v47, s41, v10
    v_and_b32 v10, 31, v1
    v_lshlrev_b32 v11, 3, v10
    s_lshl_b32 s46, s40, 8
    v_add_u32 v11, s46, v11
    global_load_dwordx2 v[6:7], v11, s[4:5]
    s_waitcnt vmcnt(0)
    s_lshl_b32 s59, s40, 12
    s_add_u32 s59, s59, 131072
    s_mov_b32 s41, s59
    v_lshrrev_b32 v10, 2, v9
    v_lshlrev_b32 v11, 3, v8
    v_add_u32 v10, v10, v11
    v_mul_u32_u24 v10, 64, v10
    v_and_b32 v11, 3, v9
    v_lshlrev_b32 v11, 3, v11
    v_add_u32 v10, v10, v11
    v_add_u32 v62, s41, v10
    v_lshlrev_b32 v63, 4, v1
    v_add_u32 v63, s55, v63
    s_cmp_eq_u32 s40, 0
    s_nop 0
    s_cbranch_scc0 L_f_nok
    v_mov_b32 v4, 147468
    s_nop 1
L_f_k_pc:
    s_sub_u32 s89, s89, 1
    s_cbranch_scc1 L_end
    ds_read_b32 v5, v4
    s_waitcnt lgkmcnt(0)
    v_readfirstlane_b32 s42, v5
    s_nop 0
    s_cmp_ge_u32 s42, 256
    s_nop 2
    s_cbranch_scc1 L_f_k_pcok
    s_sleep 16
    s_branch L_f_k_pc
L_f_k_pcok:
    v_mov_b32 v4, 147504
    ds_read_b64 v[16:17], v4
    s_lshl_b32 s42, s3, 3
    s_add_u32 s42, s42, 589824
    v_mov_b32 v4, s42
    s_waitcnt lgkmcnt(0)
    s_mov_b64 exec, 1
    global_store_dwordx2 v4, v[16:17], s[26:27] sc1
    s_mov_b64 exec, -1
    s_lshl_b32 s42, s29, 6
    s_add_u32 s42, s42, 589824
    v_and_b32 v4, 7, v1
    v_lshlrev_b32 v4, 3, v4
    v_add_u32 v4, s42, v4
    s_nop 1
L_f_k_kd:
    s_sub_u32 s89, s89, 1
    s_cbranch_scc1 L_end
    global_load_dwordx2 v[20:21], v4, s[26:27] sc1
    s_waitcnt vmcnt(0)
    v_xor_b32 v5, v16, v20
    v_xor_b32 v18, v17, v21
    v_or_b32 v5, v5, v18
    v_cmp_ne_u32 vcc, 0, v5
    s_nop 4
    s_cbranch_vccz L_f_k_kdok
    s_sleep 16
    s_branch L_f_k_kd
L_f_k_kdok:
    v_mov_b32 v4, 147512
    v_mov_b32 v5, 1
    ds_write_b32 v4, v5
    s_nop 0
L_f_nok:
    v_mov_b32 v4, 147504
    ds_read_b64 v[16:17], v4
    v_lshlrev_b32 v4, 4, v1
    v_add_u32 v4, 573440, v4
    s_waitcnt lgkmcnt(0)
    s_nop 0
L_f_clr:
    s_sub_u32 s89, s89, 1
    s_cbranch_scc1 L_end
    global_load_dwordx4 v[20:23], v4, s[26:27] sc1
    global_load_dwordx4 v[24:27], v4, s[26:27] offset:1024 sc1
    s_waitcnt vmcnt(0)
    v_xor_b32 v5, v16, v20
    v_xor_b32 v18, v16, v22
    v_or_b32 v5, v5, v18
    v_xor_b32 v18, v16, v24
    v_or_b32 v5, v5, v18
    v_xor_b32 v18, v16, v26
    v_or_b32 v5, v5, v18
    v_xor_b32 v18, v17, v21
    v_or_b32 v5, v5, v18
    v_xor_b32 v18, v17, v23
    v_or_b32 v5, v5, v18
    v_xor_b32 v18, v17, v25
    v_or_b32 v5, v5, v18
    v_xor_b32 v18, v17, v27
    v_or_b32 v5, v5, v18
    v_cmp_ne_u32 vcc, 0, v5
    s_nop 4
    s_cbranch_vccz L_f_go0
    s_sleep 32
    s_branch L_f_clr
L_f_go0:
    v_mov_b32 v4, 147464
    s_nop 1
L_f_fv:
    s_sub_u32 s89, s89, 1
    s_cbranch_scc1 L_end
    ds_read_b32 v5, v4
    s_waitcnt lgkmcnt(0)
    v_readfirstlane_b32 s42, v5
    s_nop 0
    s_cmp_lg_u32 s42, 0x7fffffff
    s_nop 2
    s_cbranch_scc1 L_f_fv_ok
    s_sleep 2
    s_branch L_f_fv
L_f_fv_ok:
    s_add_u32 m0, s59, 0
    s_add_u32 s58, s56, 0
    buffer_load_dwordx4 v44, s[64:67], s58 offen nt lds
    s_add_u32 m0, s59, 1024
    s_add_u32 s58, s56, 44032
    buffer_load_dwordx4 v44, s[64:67], s58 offen nt lds
    s_add_u32 m0, s59, 2048
    s_add_u32 s58, s56, 0
    buffer_load_dwordx4 v44, s[68:71], s58 offen nt lds
    s_add_u32 m0, s59, 3072
    s_add_u32 s58, s56, 44032
    buffer_load_dwordx4 v44, s[68:71], s58 offen nt lds
    s_add_u32 s58, s56, 88064
    buffer_load_dwordx4 v[28:31], v44, s[64:67], s58 offen nt
    s_add_u32 s58, s56, 132096
    buffer_load_dwordx4 v[32:35], v44, s[64:67], s58 offen nt
    s_add_u32 s58, s56, 88064
    buffer_load_dwordx4 v[36:39], v44, s[68:71], s58 offen nt
    s_add_u32 s58, s56, 132096
    buffer_load_dwordx4 v[40:43], v44, s[68:71], s58 offen nt
    v_mov_b32 v4, 147496
    s_nop 1
L_f_go:
    s_sub_u32 s89, s89, 1
    s_cbranch_scc1 L_end
    ds_read_b32 v5, v4
    s_waitcnt lgkmcnt(0)
    v_readfirstlane_b32 s42, v5
    s_nop 0
    s_cmp_lg_u32 s42, 0
    s_nop 2
    s_cbranch_scc1 L_f_go_ok
    s_sleep 1
    s_branch L_f_go
L_f_go_ok:
    s_add_u32 m0, s55, 8192
    s_add_u32 s58, s56, 176128
    buffer_load_dwordx4 v44, s[64:67], s58 offen nt lds
    s_add_u32 m0, s55, 9216
    s_add_u32 s58, s56, 220160
    buffer_load_dwordx4 v44, s[64:67], s58 offen nt lds
    s_add_u32 m0, s55, 10240
    s_add_u32 s58, s56, 176128
    buffer_load_dwordx4 v44, s[68:71], s58 offen nt lds
    s_add_u32 m0, s55, 11264
    s_add_u32 s58, s56, 220160
    buffer_load_dwordx4 v44, s[68:71], s58 offen nt lds
    s_add_u32 m0, s55, 12288
    s_add_u32 s58, s56, 264192
    buffer_load_dwordx4 v44, s[64:67], s58 offen nt lds
    s_add_u32 m0, s55, 13312
    s_add_u32 s58, s56, 308224
    buffer_load_dwordx4 v44, s[64:67], s58 offen nt lds
    s_add_u32 m0, s55, 14336
    s_add_u32 s58, s56, 264192
    buffer_load_dwordx4 v44, s[68:71], s58 offen nt lds
    s_add_u32 m0, s55, 15360
    s_add_u32 s58, s56, 308224
    buffer_load_dwordx4 v44, s[68:71], s58 offen nt lds
    s_add_u32 m0, s55, 16384
    s_add_u32 s58, s57, 0
    buffer_load_dwordx4 v45, s[72:75], s58 offen nt lds
    s_add_u32 m0, s55, 17408
    s_add_u32 s58, s57, 8192
    buffer_load_dwordx4 v45, s[72:75], s58 offen nt lds
    s_add_u32 m0, s55, 18432
    s_add_u32 s58, s57, 16384
    buffer_load_dwordx4 v45, s[72:75], s58 offen nt lds
    s_add_u32 m0, s55, 19456
    s_add_u32 s58, s57, 24576
    buffer_load_dwordx4 v45, s[72:75], s58 offen nt lds
    s_add_u32 m0, s55, 20480
    s_add_u32 s58, s57, 128
    buffer_load_dwordx4 v45, s[72:75], s58 offen nt lds
    s_add_u32 m0, s55, 21504
    s_add_u32 s58, s57, 8320
    buffer_load_dwordx4 v45, s[72:75], s58 offen nt lds
    s_add_u32 m0, s55, 22528
    s_add_u32 s58, s57, 16512
    buffer_load_dwordx4 v45, s[72:75], s58 offen nt lds
    s_add_u32 m0, s55, 23552
    s_add_u32 s58, s57, 24704
    buffer_load_dwordx4 v45, s[72:75], s58 offen nt lds
    s_waitcnt vmcnt(16)
    ds_write_b128 v63, v[28:31] offset:4096
    ds_write_b128 v63, v[32:35] offset:5120
    ds_write_b128 v63, v[36:39] offset:6144
    ds_write_b128 v63, v[40:43] offset:7168
    s_waitcnt lgkmcnt(0)
    v_lshlrev_b32 v48, 16, v6
    v_and_b32 v49, s43, v6
    v_lshlrev_b32 v50, 16, v7
    v_and_b32 v51, s43, v7
    v_and_b32 v10, 31, v1
    v_lshlrev_b32 v14, 4, v10
    v_lshrrev_b32 v11, 5, v1
    v_lshlrev_b32 v11, 11, v11
    v_add_u32 v14, v14, v11
    s_lshl_b32 s46, s40, 9
    s_add_u32 s46, s46, 167936
    v_add_u32 v14, s46, v14
    v_add_u32 v15, 4096, v14
    v_add_u32 v2, 8192, v14
    v_add_u32 v3, 12288, v14
    s_lshl_b32 s47, s40, 3
    s_add_u32 s47, s47, 150080
    v_mov_b32 v52, s47
    v_mov_b32 v53, 150080
    s_lshl_b32 s47, s40, 8
    s_add_u32 s47, s47, 151104
    v_lshlrev_b32 v54, 3, v10
    v_add_u32 v54, s47, v54
    v_lshlrev_b32 v55, 4, v8
    v_add_u32 v55, s47, v55
    s_lshl_b32 s47, s40, 6
    s_add_u32 s47, s47, 152128
    v_lshlrev_b32 v58, 1, v10
    v_add_u32 v58, s47, v58
    v_lshlrev_b32 v59, 4, v8
    v_add_u32 v59, s47, v59
    s_lshl_b32 s47, s44, 11
    s_lshl_b32 s46, s40, 9
    s_add_u32 s47, s47, s46
    s_add_u32 s47, s47, 196608
    v_lshlrev_b32 v60, 2, v1
    v_add_u32 v60, s47, v60
    s_mov_b32 s60, 0xffff0000
    s_mov_b32 s61, 0xffff0000
    s_mov_b32 s62, 0
    s_mov_b32 s63, -1
    s_lshl_b32 s47, s40, 8
    s_add_u32 s47, s47, 152384
    v_lshlrev_b32 v56, 2, v9
    v_add_u32 v56, s47, v56
    v_lshlrev_b32 v57, 2, v1
    v_add_u32 v57, 152384, v57
    s_waitcnt vmcnt(8)
    ds_read_b64_tr_b16 v[64:65], v62 offset:0
    ds_read_b64_tr_b16 v[66:67], v62 offset:256
    ds_read_b64_tr_b16 v[68:69], v62 offset:32
    ds_read_b64_tr_b16 v[70:71], v62 offset:288
    ds_read_b64_tr_b16 v[72:73], v62 offset:2048
    ds_read_b64_tr_b16 v[74:75], v62 offset:2304
    ds_read_b64_tr_b16 v[76:77], v62 offset:2080
    ds_read_b64_tr_b16 v[78:79], v62 offset:2336
    s_waitcnt lgkmcnt(0)
    ds_read_b64_tr_b16 v[80:81], v46 offset:4096
    ds_read_b64_tr_b16 v[82:83], v46 offset:4352
    ds_read_b64_tr_b16 v[84:85], v46 offset:4128
    ds_read_b64_tr_b16 v[86:87], v46 offset:4384
    ds_read_b64_tr_b16 v[88:89], v46 offset:6144
    ds_read_b64_tr_b16 v[90:91], v46 offset:6400
    ds_read_b64_tr_b16 v[92:93], v46 offset:6176
    ds_read_b64_tr_b16 v[94:95], v46 offset:6432
    s_waitcnt lgkmcnt(0)
    ds_read_b64_tr_b16 v[96:97], v46 offset:8192
    ds_read_b64_tr_b16 v[98:99], v46 offset:8448
    ds_read_b64_tr_b16 v[100:101], v46 offset:8224
    ds_read_b64_tr_b16 v[102:103], v46 offset:8480
    ds_read_b64_tr_b16 v[104:105], v46 offset:10240
    ds_read_b64_tr_b16 v[106:107], v46 offset:10496
    ds_read_b64_tr_b16 v[108:109], v46 offset:10272
    ds_read_b64_tr_b16 v[110:111], v46 offset:10528
    s_waitcnt lgkmcnt(0)
    ds_read_b64_tr_b16 v[112:113], v46 offset:12288
    ds_read_b64_tr_b16 v[114:115], v46 offset:12544
    ds_read_b64_tr_b16 v[116:117], v46 offset:12320
    ds_read_b64_tr_b16 v[118:119], v46 offset:12576
    ds_read_b64_tr_b16 v[120:121], v46 offset:14336
    ds_read_b64_tr_b16 v[122:123], v46 offset:14592
    ds_read_b64_tr_b16 v[124:125], v46 offset:14368
    ds_read_b64_tr_b16 v[126:127], v46 offset:14624
    s_waitcnt lgkmcnt(0)
    s_waitcnt vmcnt(0)
    ds_read_b64_tr_b16 v[128:129], v47 offset:0
    ds_read_b64_tr_b16 v[130:131], v47 offset:512
    ds_read_b64_tr_b16 v[132:133], v47 offset:32
    ds_read_b64_tr_b16 v[134:135], v47 offset:544
    ds_read_b64_tr_b16 v[136:137], v47 offset:64
    ds_read_b64_tr_b16 v[138:139], v47 offset:576
    ds_read_b64_tr_b16 v[140:141], v47 offset:96
    ds_read_b64_tr_b16 v[142:143], v47 offset:608
    s_waitcnt lgkmcnt(0)
    ds_read_b64_tr_b16 v[144:145], v47 offset:4096
    ds_read_b64_tr_b16 v[146:147], v47 offset:4608
    ds_read_b64_tr_b16 v[148:149], v47 offset:4128
    ds_read_b64_tr_b16 v[150:151], v47 offset:4640
    ds_read_b64_tr_b16 v[152:153], v47 offset:4160
    ds_read_b64_tr_b16 v[154:155], v47 offset:4672
    ds_read_b64_tr_b16 v[156:157], v47 offset:4192
    ds_read_b64_tr_b16 v[158:159], v47 offset:4704
    s_waitcnt lgkmcnt(0)
L_f_poll:
    s_sub_u32 s89, s89, 1
    s_cbranch_scc1 L_end
    global_load_dwordx4 v[16:19], v14, s[26:27] sc1
    global_load_dwordx4 v[20:23], v15, s[26:27] sc1
    global_load_dwordx4 v[24:27], v2, s[26:27] sc1
    global_load_dwordx4 v[28:31], v3, s[26:27] sc1
    s_waitcnt vmcnt(0)
    v_max3_u32 v61, v16, v17, v18
    v_max3_u32 v61, v61, v19, v20
    v_max3_u32 v61, v61, v21, v22
    v_max3_u32 v61, v61, v23, v24
    v_max3_u32 v61, v61, v25, v26
    v_max3_u32 v61, v61, v27, v28
    v_max3_u32 v61, v61, v29, v30
    v_max_u32 v61, v61, v31
    v_cmp_eq_u32 vcc, -1, v61
    s_nop 4
    s_cbranch_vccnz L_f_poll
    v_pk_add_f32 v[4:5], v[16:17], v[20:21]
    v_pk_add_f32 v[6:7], v[18:19], v[22:23]
    v_pk_add_f32 v[10:11], v[24:25], v[28:29]
    v_pk_add_f32 v[12:13], v[26:27], v[30:31]
    v_pk_add_f32 v[4:5], v[4:5], v[10:11]
    v_pk_add_f32 v[6:7], v[6:7], v[12:13]
    v_mov_b32 v160, v4
    v_mov_b32 v161, v5
    v_mov_b32 v162, v6
    v_mov_b32 v163, v7
    v_permlane32_swap_b32 v4, v160
    v_permlane32_swap_b32 v5, v161
    v_permlane32_swap_b32 v6, v162
    v_permlane32_swap_b32 v7, v163
    v_pk_add_f32 v[4:5], v[4:5], v[160:161]
    v_pk_add_f32 v[6:7], v[6:7], v[162:163]
    v_cvt_pk_bf16_f32 v160, v4, v5
    v_cvt_pk_bf16_f32 v161, v6, v7
    v_lshlrev_b32 v4, 16, v160
    v_and_b32 v5, s43, v160
    v_lshlrev_b32 v6, 16, v161
    v_and_b32 v7, s43, v161
    v_pk_add_f32 v[4:5], v[4:5], v[48:49]
    v_pk_add_f32 v[6:7], v[6:7], v[50:51]
    v_cvt_pk_bf16_f32 v160, v4, v5
    v_cvt_pk_bf16_f32 v161, v6, v7
    v_lshlrev_b32 v4, 16, v160
    v_and_b32 v5, s43, v160
    v_lshlrev_b32 v6, 16, v161
    v_and_b32 v7, s43, v161
    v_add_f32 v8, v4, v5
    v_mul_f32 v9, v4, v4
    v_add_f32 v10, v6, v7
    v_fmac_f32 v9, v5, v5
    v_add_f32 v8, v8, v10
    v_fmac_f32 v9, v6, v6
    v_fmac_f32 v9, v7, v7
    v_add_f32_dpp v8, v8, v8 row_ror:8 row_mask:0xf bank_mask:0xf
    s_nop 0
    v_add_f32_dpp v9, v9, v9 row_ror:8 row_mask:0xf bank_mask:0xf
    v_add_f32_dpp v8, v8, v8 row_ror:4 row_mask:0xf bank_mask:0xf
    s_nop 0
    v_add_f32_dpp v9, v9, v9 row_ror:4 row_mask:0xf bank_mask:0xf
    v_add_f32_dpp v8, v8, v8 row_ror:2 row_mask:0xf bank_mask:0xf
    s_nop 0
    v_add_f32_dpp v9, v9, v9 row_ror:2 row_mask:0xf bank_mask:0xf
    v_add_f32_dpp v8, v8, v8 row_ror:1 row_mask:0xf bank_mask:0xf
    s_nop 0
    v_add_f32_dpp v9, v9, v9 row_ror:1 row_mask:0xf bank_mask:0xf
    v_mov_b32 v10, v8
    v_mov_b32 v11, v9
    s_nop 0
    v_permlane16_swap_b32 v8, v10
    v_permlane16_swap_b32 v9, v11
    v_add_f32 v8, v8, v10
    v_add_f32 v9, v9, v11
    ds_write_b64 v52, v[8:9]
    s_waitcnt lgkmcnt(0)
    s_barrier
    ds_read_b128 v[8:11], v53
    ds_read_b128 v[12:15], v53 offset:16
    s_waitcnt lgkmcnt(0)
    v_pk_add_f32 v[8:9], v[8:9], v[10:11]
    v_pk_add_f32 v[12:13], v[12:13], v[14:15]
    v_pk_add_f32 v[8:9], v[8:9], v[12:13]
    v_mul_f32 v8, 0x3b000000, v8
    v_mul_f32 v9, 0x3b000000, v9
    v_cvt_pk_bf16_f32 v10, v8, v8
    v_fma_f32 v9, -v8, v8, v9
    v_and_b32 v10, s43, v10
    v_max_f32 v9, 0, v9
    v_cvt_pk_bf16_f32 v9, v9, v9
    v_sub_f32 v4, v4, v10
    v_and_b32 v9, s43, v9
    v_sub_f32 v5, v5, v10
    v_add_f32 v9, 0x3727c5ac, v9
    v_sub_f32 v6, v6, v10
    v_cvt_pk_bf16_f32 v9, v9, v9
    v_sub_f32 v7, v7, v10
    v_and_b32 v9, s43, v9
    v_cvt_pk_bf16_f32 v160, v4, v5
    v_sqrt_f32 v9, v9
    v_cvt_pk_bf16_f32 v161, v6, v7
    v_lshlrev_b32 v4, 16, v160
    v_cvt_pk_bf16_f32 v9, v9, v9
    v_and_b32 v5, s43, v160
    v_and_b32 v12, s43, v9
    v_lshlrev_b32 v6, 16, v161
    v_rcp_f32 v12, v12
    v_and_b32 v7, s43, v161
    v_pk_mul_f32 v[4:5], v[4:5], v[12:13] op_sel_hi:[1,0]
    v_pk_mul_f32 v[6:7], v[6:7], v[12:13] op_sel_hi:[1,0]
    v_cvt_pk_bf16_f32 v160, v4, v5
    v_cvt_pk_bf16_f32 v161, v6, v7
    ds_write_b64 v54, v[160:161]
    s_waitcnt vmcnt(0) lgkmcnt(0)
    ds_read_b128 v[16:19], v55 offset:0
    ds_read_b128 v[20:23], v55 offset:64
    ds_read_b128 v[24:27], v55 offset:128
    ds_read_b128 v[28:31], v55 offset:192
    s_waitcnt lgkmcnt(3)
    v_mfma_f32_16x16x32_bf16 v[32:35], v[16:19], v[64:67], 0
    v_mfma_f32_16x16x32_bf16 v[36:39], v[16:19], v[68:71], 0
    v_mfma_f32_16x16x32_bf16 v[40:43], v[16:19], v[72:75], 0
    v_mfma_f32_16x16x32_bf16 v[44:47], v[16:19], v[76:79], 0
    s_waitcnt lgkmcnt(2)
    v_mfma_f32_16x16x32_bf16 v[32:35], v[20:23], v[80:83], v[32:35]
    v_mfma_f32_16x16x32_bf16 v[36:39], v[20:23], v[84:87], v[36:39]
    v_mfma_f32_16x16x32_bf16 v[40:43], v[20:23], v[88:91], v[40:43]
    v_mfma_f32_16x16x32_bf16 v[44:47], v[20:23], v[92:95], v[44:47]
    s_waitcnt lgkmcnt(1)
    v_mfma_f32_16x16x32_bf16 v[32:35], v[24:27], v[96:99], v[32:35]
    v_mfma_f32_16x16x32_bf16 v[36:39], v[24:27], v[100:103], v[36:39]
    v_mfma_f32_16x16x32_bf16 v[40:43], v[24:27], v[104:107], v[40:43]
    v_mfma_f32_16x16x32_bf16 v[44:47], v[24:27], v[108:111], v[44:47]
    s_waitcnt lgkmcnt(0)
    v_mfma_f32_16x16x32_bf16 v[32:35], v[28:31], v[112:115], v[32:35]
    v_mfma_f32_16x16x32_bf16 v[36:39], v[28:31], v[116:119], v[36:39]
    v_mfma_f32_16x16x32_bf16 v[40:43], v[28:31], v[120:123], v[40:43]
    v_mfma_f32_16x16x32_bf16 v[44:47], v[28:31], v[124:127], v[44:47]
    s_nop 4
    ds_write_b32 v56, v32 offset:0
    ds_write_b32 v56, v36 offset:64
    ds_write_b32 v56, v40 offset:128
    ds_write_b32 v56, v44 offset:192
    s_waitcnt lgkmcnt(0)
    s_barrier
    ds_read_b32 v12, v57
    ds_read_b32 v13, v57 offset:256
    ds_read_b32 v14, v57 offset:512
    ds_read_b32 v15, v57 offset:768
    s_waitcnt lgkmcnt(0)
    v_add_f32 v12, v12, v13
    v_add_f32 v14, v14, v15
    v_add_f32 v12, v12, v14
    v_cvt_pk_bf16_f32 v12, v12, v12
    v_and_b32 v12, s43, v12
    v_mov_b32 v13, v12
    s_nop 1
    v_permlane32_swap_b32 v12, v13
    v_mul_f32 v12, v12, v13
    v_cvt_pk_bf16_f32 v12, v12, v12
    ds_write_b16 v58, v12
    s_waitcnt lgkmcnt(0)
    ds_read_b128 v[16:19], v59
    s_waitcnt lgkmcnt(0)
    v_mfma_f32_16x16x32_bf16 v[20:23], v[16:19], v[128:131], 0
    v_mfma_f32_16x16x32_bf16 v[24:27], v[16:19], v[132:135], 0
    v_mfma_f32_16x16x32_bf16 v[28:31], v[16:19], v[136:139], 0
    v_mfma_f32_16x16x32_bf16 v[32:35], v[16:19], v[140:143], 0
    v_mfma_f32_16x16x32_bf16 v[36:39], v[16:19], v[144:147], 0
    v_mfma_f32_16x16x32_bf16 v[40:43], v[16:19], v[148:151], 0
    v_mfma_f32_16x16x32_bf16 v[44:47], v[16:19], v[152:155], 0
    v_mfma_f32_16x16x32_bf16 v[48:51], v[16:19], v[156:159], 0
    s_nop 1
    v_cndmask_b32 v12, v20, v24, s[60:61]
    s_nop 0
    v_cndmask_b32 v13, v28, v32, s[60:61]
    v_cndmask_b32 v12, v12, v13, s[62:63]
    global_store_dword v60, v12, s[26:27] offset:0 sc1
    v_cndmask_b32 v14, v36, v40, s[60:61]
    v_cndmask_b32 v15, v44, v48, s[60:61]
    v_cndmask_b32 v14, v14, v15, s[62:63]
    global_store_dword v60, v14, s[26:27] offset:256 sc1
    s_endpgm
L_t_o:
    v_and_b32 v10, 7, v1
    v_lshlrev_b32 v11, 3, v10
    s_lshl_b32 s46, s44, 6
    v_add_u32 v11, s46, v11
    global_load_dwordx2 v[6:7], v11, s[4:5]
    v_mov_b32 v3, v11
    v_lshlrev_b32 v14, 4, v10
    v_lshrrev_b32 v12, 3, v1
    v_lshlrev_b32 v12, 11, v12
    v_add_u32 v14, v14, v12
    s_lshl_b32 s46, s44, 7
    v_add_u32 v14, s46, v14
    v_add_u32 v15, 167936, v14
    s_add_u32 s32, s26, 196608
    s_addc_u32 s33, s27, 0
    s_and_b32 s33, s33, 0xffff
    s_mov_b32 s34, 88064
    s_mov_b32 s35, 0x20000
    v_mov_b32 v4, 147500
    s_waitcnt vmcnt(0)
    s_nop 0
L_o_qw:
    s_sub_u32 s89, s89, 1
    s_cbranch_scc1 L_end
    ds_read_b32 v5, v4
    s_waitcnt lgkmcnt(0)
    v_readfirstlane_b32 s42, v5
    s_nop 0
    s_cmp_lg_u32 s42, 0
    s_nop 2
    s_cbranch_scc1 L_o_qw_ok
    s_sleep 8
    s_branch L_o_qw
L_o_qw_ok:
    s_cmp_eq_u32 s40, 0
    s_cbranch_scc0 L_o_nok
    v_mov_b32 v4, 147468
    s_nop 1
L_o_k_pc:
    s_sub_u32 s89, s89, 1
    s_cbranch_scc1 L_end
    ds_read_b32 v5, v4
    s_waitcnt lgkmcnt(0)
    v_readfirstlane_b32 s42, v5
    s_nop 0
    s_cmp_ge_u32 s42, 256
    s_nop 2
    s_cbranch_scc1 L_o_k_pcok
    s_sleep 16
    s_branch L_o_k_pc
L_o_k_pcok:
    v_mov_b32 v4, 147504
    ds_read_b64 v[16:17], v4
    s_lshl_b32 s42, s3, 3
    s_add_u32 s42, s42, 589824
    v_mov_b32 v4, s42
    s_waitcnt lgkmcnt(0)
    s_mov_b64 exec, 1
    global_store_dwordx2 v4, v[16:17], s[26:27] sc1
    s_mov_b64 exec, -1
    s_lshl_b32 s42, s29, 6
    s_add_u32 s42, s42, 589824
    v_and_b32 v4, 7, v1
    v_lshlrev_b32 v4, 3, v4
    v_add_u32 v4, s42, v4
    s_nop 1
L_o_k_kd:
    s_sub_u32 s89, s89, 1
    s_cbranch_scc1 L_end
    global_load_dwordx2 v[20:21], v4, s[26:27] sc1
    s_waitcnt vmcnt(0)
    v_xor_b32 v5, v16, v20
    v_xor_b32 v18, v17, v21
    v_or_b32 v5, v5, v18
    v_cmp_ne_u32 vcc, 0, v5
    s_nop 4
    s_cbranch_vccz L_o_k_kdok
    s_sleep 16
    s_branch L_o_k_kd
L_o_k_kdok:
    v_mov_b32 v4, 147512
    v_mov_b32 v5, 1
    ds_write_b32 v4, v5
    s_nop 0
L_o_nok:
    v_mov_b32 v4, 147504
    ds_read_b64 v[16:17], v4
    v_lshlrev_b32 v4, 4, v1
    v_add_u32 v4, 573440, v4
    s_waitcnt lgkmcnt(0)
    s_nop 0
L_o_clr:
    s_sub_u32 s89, s89, 1
    s_cbranch_scc1 L_end
    global_load_dwordx4 v[20:23], v4, s[26:27] sc1
    global_load_dwordx4 v[24:27], v4, s[26:27] offset:1024 sc1
    s_waitcnt vmcnt(0)
    v_xor_b32 v5, v16, v20
    v_xor_b32 v18, v16, v22
    v_or_b32 v5, v5, v18
    v_xor_b32 v18, v16, v24
    v_or_b32 v5, v5, v18
    v_xor_b32 v18, v16, v26
    v_or_b32 v5, v5, v18
    v_xor_b32 v18, v17, v21
    v_or_b32 v5, v5, v18
    v_xor_b32 v18, v17, v23
    v_or_b32 v5, v5, v18
    v_xor_b32 v18, v17, v25
    v_or_b32 v5, v5, v18
    v_xor_b32 v18, v17, v27
    v_or_b32 v5, v5, v18
    v_cmp_ne_u32 vcc, 0, v5
    s_nop 4
    s_cbranch_vccz L_o_go0
    s_sleep 32
    s_branch L_o_clr
L_o_go0:
    s_cmp_eq_u32 s44, 0
    s_cbranch_scc0 L_o_keep
    v_mov_b32 v4, 0
    v_mov_b32 v20, 0
    v_mov_b32 v21, 0
    s_mov_b64 exec, 1
    global_store_dwordx2 v4, v[20:21], s[24:25] sc1
    s_mov_b64 exec, -1
L_o_keep:
    v_mov_b32 v4, 147496
    s_nop 1
L_o_go:
    s_sub_u32 s89, s89, 1
    s_cbranch_scc1 L_end
    ds_read_b32 v5, v4
    s_waitcnt lgkmcnt(0)
    v_readfirstlane_b32 s42, v5
    s_nop 0
    s_cmp_lg_u32 s42, 0
    s_nop 2
    s_cbranch_scc1 L_o_go_ok
    s_sleep 1
    s_branch L_o_go
L_o_go_ok:
    v_mov_b32 v70, v3
    s_nop 1
L_o_polly:
    s_sub_u32 s89, s89, 1
    s_cbranch_scc1 L_end
    global_load_dwordx4 v[16:19], v15, s[26:27] sc1
    s_waitcnt vmcnt(0)
    v_max3_u32 v28, v16, v17, v18
    v_max_u32 v28, v28, v19
    v_cmp_eq_u32 vcc, -1, v28
    s_nop 4
    s_cbranch_vccnz L_o_polly
    v_mov_b32 v72, v16
    v_mov_b32 v73, v17
    v_mov_b32 v74, v18
    v_mov_b32 v75, v19
    v_add_f32_dpp v72, v72, v72 row_ror:8 row_mask:0xf bank_mask:0xf
    v_add_f32_dpp v73, v73, v73 row_ror:8 row_mask:0xf bank_mask:0xf
    v_add_f32_dpp v74, v74, v74 row_ror:8 row_mask:0xf bank_mask:0xf
    v_add_f32_dpp v75, v75, v75 row_ror:8 row_mask:0xf bank_mask:0xf
    v_mov_b32 v76, v72
    v_mov_b32 v77, v73
    v_mov_b32 v78, v74
    v_mov_b32 v79, v75
    v_permlane16_swap_b32 v72, v76
    v_permlane16_swap_b32 v73, v77
    v_permlane16_swap_b32 v74, v78
    v_permlane16_swap_b32 v75, v79
    v_add_f32 v72, v72, v76
    v_add_f32 v73, v73, v77
    v_add_f32 v74, v74, v78
    v_add_f32 v75, v75, v79
    v_mov_b32 v76, v72
    v_mov_b32 v77, v73
    v_mov_b32 v78, v74
    v_mov_b32 v79, v75
    v_permlane32_swap_b32 v72, v76
    v_permlane32_swap_b32 v73, v77
    v_permlane32_swap_b32 v74, v78
    v_permlane32_swap_b32 v75, v79
    v_add_f32 v72, v72, v76
    v_add_f32 v73, v73, v77
    v_add_f32 v74, v74, v78
    v_add_f32 v75, v75, v79
    v_cvt_pk_bf16_f32 v72, v72, v73
    v_cvt_pk_bf16_f32 v73, v74, v75
    v_lshlrev_b32 v76, 16, v72
    v_and_b32 v77, s43, v72
    v_lshlrev_b32 v78, 16, v73
    v_and_b32 v79, s43, v73
    v_lshlrev_b32 v80, 16, v6
    v_and_b32 v81, s43, v6
    v_lshlrev_b32 v82, 16, v7
    v_and_b32 v83, s43, v7
    v_pk_add_f32 v[76:77], v[76:77], v[80:81]
    v_pk_add_f32 v[78:79], v[78:79], v[82:83]
    v_cvt_pk_bf16_f32 v72, v76, v77
    v_cvt_pk_bf16_f32 v73, v78, v79
    v_lshlrev_b32 v66, 16, v72
    v_and_b32 v67, s43, v72
    v_lshlrev_b32 v68, 16, v73
    v_and_b32 v69, s43, v73
    s_waitcnt vmcnt(0)
    s_nop 0
L_o_pollp:
    s_sub_u32 s89, s89, 1
    s_cbranch_scc1 L_end
    s_mov_b32 s46, 0
    buffer_load_dwordx4 v[16:19], v14, s[32:35], s46 offen sc1
    s_mov_b32 s46, 16384
    buffer_load_dwordx4 v[20:23], v14, s[32:35], s46 offen sc1
    s_mov_b32 s46, 32768
    buffer_load_dwordx4 v[24:27], v14, s[32:35], s46 offen sc1
    s_mov_b32 s46, 49152
    buffer_load_dwordx4 v[28:31], v14, s[32:35], s46 offen sc1
    s_mov_b32 s46, 65536
    buffer_load_dwordx4 v[32:35], v14, s[32:35], s46 offen sc1
    s_mov_b32 s46, 81920
    buffer_load_dwordx4 v[36:39], v14, s[32:35], s46 offen sc1
    s_waitcnt vmcnt(0)
    v_max3_u32 v71, v16, v17, v18
    v_max3_u32 v71, v71, v19, v20
    v_max3_u32 v71, v71, v21, v22
    v_max3_u32 v71, v71, v23, v24
    v_max3_u32 v71, v71, v25, v26
    v_max3_u32 v71, v71, v27, v28
    v_max3_u32 v71, v71, v29, v30
    v_max3_u32 v71, v71, v31, v32
    v_max3_u32 v71, v71, v33, v34
    v_max3_u32 v71, v71, v35, v36
    v_max3_u32 v71, v71, v37, v38
    v_max_u32 v71, v71, v39
    v_cmp_eq_u32 vcc, -1, v71
    s_nop 4
    s_cbranch_vccnz L_o_pollp
    v_pk_add_f32 v[72:73], v[16:17], v[20:21]
    v_pk_add_f32 v[74:75], v[18:19], v[22:23]
    v_pk_add_f32 v[76:77], v[24:25], v[28:29]
    v_pk_add_f32 v[78:79], v[26:27], v[30:31]
    v_pk_add_f32 v[80:81], v[32:33], v[36:37]
    v_pk_add_f32 v[82:83], v[34:35], v[38:39]
    v_pk_add_f32 v[72:73], v[72:73], v[76:77]
    v_pk_add_f32 v[74:75], v[74:75], v[78:79]
    v_pk_add_f32 v[72:73], v[72:73], v[80:81]
    v_pk_add_f32 v[74:75], v[74:75], v[82:83]
    s_nop 0
    v_add_f32_dpp v72, v72, v72 row_ror:8 row_mask:0xf bank_mask:0xf
    v_add_f32_dpp v73, v73, v73 row_ror:8 row_mask:0xf bank_mask:0xf
    v_add_f32_dpp v74, v74, v74 row_ror:8 row_mask:0xf bank_mask:0xf
    v_add_f32_dpp v75, v75, v75 row_ror:8 row_mask:0xf bank_mask:0xf
    v_mov_b32 v76, v72
    v_mov_b32 v77, v73
    v_mov_b32 v78, v74
    v_mov_b32 v79, v75
    v_permlane16_swap_b32 v72, v76
    v_permlane16_swap_b32 v73, v77
    v_permlane16_swap_b32 v74, v78
    v_permlane16_swap_b32 v75, v79
    v_add_f32 v72, v72, v76
    v_add_f32 v73, v73, v77
    v_add_f32 v74, v74, v78
    v_add_f32 v75, v75, v79
    v_mov_b32 v76, v72
    v_mov_b32 v77, v73
    v_mov_b32 v78, v74
    v_mov_b32 v79, v75
    v_permlane32_swap_b32 v72, v76
    v_permlane32_swap_b32 v73, v77
    v_permlane32_swap_b32 v74, v78
    v_permlane32_swap_b32 v75, v79
    v_add_f32 v72, v72, v76
    v_add_f32 v73, v73, v77
    v_add_f32 v74, v74, v78
    v_add_f32 v75, v75, v79
    v_cvt_pk_bf16_f32 v72, v72, v73
    v_cvt_pk_bf16_f32 v73, v74, v75
    v_lshlrev_b32 v76, 16, v72
    v_and_b32 v77, s43, v72
    v_lshlrev_b32 v78, 16, v73
    v_and_b32 v79, s43, v73
    v_pk_add_f32 v[76:77], v[76:77], v[66:67]
    v_pk_add_f32 v[78:79], v[78:79], v[68:69]
    v_cvt_pk_bf16_f32 v72, v76, v77
    v_cvt_pk_bf16_f32 v73, v78, v79
    s_mov_b64 exec, 0xff
    global_store_dwordx2 v70, v[72:73], s[22:23]
    s_mov_b64 exec, -1
L_end:
    s_endpgm
.section .rodata,"a"
.p2align 6
.amdhsa_kernel sequential_preLN__gqa_block_cached__glu_gated_bilinear__decode_kernel
  .amdhsa_next_free_vgpr 168
  .amdhsa_next_free_sgpr 96
  .amdhsa_accum_offset 168
  .amdhsa_group_segment_fixed_size 0
  .amdhsa_kernarg_size 96
  .amdhsa_user_sgpr_count 2
  .amdhsa_user_sgpr_kernarg_segment_ptr 1
  .amdhsa_system_sgpr_workgroup_id_x 1
.end_amdhsa_kernel
```
